```python
import torch

def _softmax(x, axis=-1):
    return torch.softmax(x, dim=axis)
def _gelu(x):
    return torch.nn.functional.gelu(x, approximate="tanh")
def _silu(x):
    return torch.nn.functional.silu(x)
def _sigmoid(x):
    return torch.sigmoid(x)
def _layernorm(x, axis=-1, eps=1e-5):
    m = x.mean(dim=axis, keepdim=True)
    v = x.var(dim=axis, keepdim=True, unbiased=False)
    return (x - m) / torch.sqrt(v + eps)
def _scatter_add(tgt, idx, src, axis=0):
    return tgt.clone().index_add_(axis, idx, src)
def _segment_sum(src, seg, n):
    out = torch.zeros((n,) + src.shape[1:], dtype=src.dtype)
    return out.index_add_(0, seg, src)
def _pad(x, pw):
    flat = tuple(v for pair in reversed(pw) for v in pair)
    return torch.nn.functional.pad(x, flat)

kernel_name = 'concat_heads__ssm_conv_s4d__linear_attn_block__prompt'

def setup_inputs():

    _w = (lambda a: (lambda t: t.to(torch.bfloat16) if t.is_floating_point() else t)(torch.as_tensor(a)))
    def _A_setup():
        Bsz, L, D, N = 1, 2048, 448, 256
        return {
            "u": _w((lambda *s: torch.randn(*s, dtype=torch.bfloat16) * 0.05)(Bsz, L, D)),
            "log_A_real": _w((lambda *s: torch.randn(*s, dtype=torch.bfloat16) * 6.4)(D, N) * 0.5),
            "A_imag": _w((lambda *s: torch.randn(*s, dtype=torch.bfloat16) * 0.05)(D, N) * 3.14),
            "C_real": _w((lambda *s: torch.randn(*s, dtype=torch.bfloat16) * 0.2)(D, N) / N ** 0.5),
            "C_imag": _w((lambda *s: torch.randn(*s, dtype=torch.bfloat16) * 0.2)(D, N) / N ** 0.5),
            "log_dt": _w((lambda *s: torch.randn(*s, dtype=torch.bfloat16) * 0.05)(D) * 0.5 - 4.0),
            "D_skip": _w((lambda *s: torch.randn(*s, dtype=torch.bfloat16) * 0.05)(D)),
        }
    _A_in = _A_setup()

    def _B_setup():
        B, S, D = 1, 2048, 448
        return {
            "x": _w((lambda *s: torch.randn(*s, dtype=torch.bfloat16) * 0.05)(B, S, D)),
            "wqkv": _w((lambda *s: torch.randn(*s, dtype=torch.bfloat16) * 0.8)(D, 3 * D)),
            "wo": _w((lambda *s: torch.randn(*s, dtype=torch.bfloat16) * 0.05)(D, D)),
        }
    _B_in = _B_setup()

    return {
        "A_u": _A_in["u"],
        "A_log_A_real": _A_in["log_A_real"],
        "A_A_imag": _A_in["A_imag"],
        "A_C_real": _A_in["C_real"],
        "A_C_imag": _A_in["C_imag"],
        "A_log_dt": _A_in["log_dt"],
        "A_D_skip": _A_in["D_skip"],
        "B_x": _B_in["x"],
        "B_wqkv": _B_in["wqkv"],
        "B_wo": _B_in["wo"],
    }

def reference(A_u, A_log_A_real, A_A_imag, A_C_real, A_C_imag, A_log_dt, A_D_skip, B_x, B_wqkv, B_wo):
    def _A_ref(u, log_A_real, A_imag, C_real, C_imag, log_dt, D_skip):
        L = u.shape[1]
        dt = torch.exp(log_dt)
        A = -torch.exp(log_A_real) + 1j * A_imag
        C = (C_real + 1j * C_imag) * dt[:, None]
        pos = (lambda x, dt: x.to(dt))(torch.arange(L), log_dt.dtype)
        P = torch.exp((A * dt[:, None])[:, :, None] * pos[None, None, :])
        K = 2.0 * torch.einsum("dn,dnl->dl", C, P).real
        L2 = 2 * L
        u_t = (lambda x, *d: x.permute(*d))(u, 0, 2, 1)
        Kf = (lambda x, *a, **k: torch.fft.rfft(x.float(), *a, **k))(K, L2)
        Uf = (lambda x, *a, **k: torch.fft.rfft(x.float(), *a, **k))(u_t, L2)
        y = (lambda x, *a, **k: torch.fft.irfft(x, *a, **k).to(torch.bfloat16))(Uf * Kf[None, :, :], L2)[:, :, :L]
        y = (lambda x, *d: x.permute(*d))(y, 0, 2, 1)
        return y + u * D_skip[None, None, :]

    def _B_ref(x, wqkv, wo):
        B, S, D = x.shape
        H = 16; Dh = D // H
        qkv = (lambda x, *d: x.permute(*d))((x @ wqkv).reshape(B, S, 3, H, Dh), 2, 0, 3, 1, 4)
        q, k, v = qkv[0], qkv[1], qkv[2]
        phi = lambda t: torch.where(t > 0, t + 1, torch.exp(t)) + 1e-6
        pq, pk = phi(q), phi(k)
        kv = torch.einsum("bhsd,bhse->bhde", pk, v)
        z = torch.einsum("bhsd->bhd", pk)
        num = torch.einsum("bhqd,bhde->bhqe", pq, kv)
        den = torch.einsum("bhqd,bhd->bhq", pq, z)[..., None] + 1e-6
        o = num / den
        return (lambda x, *d: x.permute(*d))(o, 0, 2, 1, 3).reshape(B, S, D) @ wo

    a = _A_ref(A_u, A_log_A_real, A_A_imag, A_C_real, A_C_imag, A_log_dt, A_D_skip)
    b = _B_ref(B_x, B_wqkv, B_wo)
    return torch.concatenate([a, b], axis=-1)
```

```asm
; @launch grid=(256,1,1) block=(512,1,1) lds=163840
.amdgcn_target "amdgcn-amd-amdhsa--gfx950"
.text
.globl concat_heads__ssm_conv_s4d__linear_attn_block__prompt_kernel
.p2align 8
.type concat_heads__ssm_conv_s4d__linear_attn_block__prompt_kernel,@function
concat_heads__ssm_conv_s4d__linear_attn_block__prompt_kernel:
  s_cmp_ge_u32 s2, 256
  s_cbranch_scc1 L_end
  s_load_dwordx16 s[16:31], s[0:1], 0
  s_load_dwordx8 s[32:39], s[0:1], 64
  s_load_dwordx2 s[40:41], s[0:1], 96
  v_lshrrev_b32 v1, 6, v0
  v_and_b32 v2, 63, v0
  s_and_b32 s3, s2, 7
  s_lshr_b32 s4, s2, 3
  v_readfirstlane_b32 s5, v1
  s_and_b32 s6, s4, 3
  s_cmp_lg_u32 s6, 0
  s_cbranch_scc1 L_nopf
  s_cmp_ge_u32 s5, 4
  s_cbranch_scc1 L_nopf
  s_getpc_b64 s[60:61]
L_pc:
  s_sub_u32 s60, s60, L_pc-concat_heads__ssm_conv_s4d__linear_attn_block__prompt_kernel
  s_subb_u32 s61, s61, 0
  v_lshlrev_b32 v250, 7, v0
  global_load_dword v251, v250, s[60:61]
L_nopf:
  s_cmp_ge_u32 s4, 24
  s_cbranch_scc1 L_a
  s_mul_i32 s7, s3, 24
  s_add_u32 s7, s7, s4
  s_and_b32 s6, s7, 0xe0
  s_add_u32 s7, s7, s6
  s_lshr_b32 s65, s5, 2
  s_cmp_ge_u32 s5, 4
  s_cbranch_scc1 L_g_dec
  v_lshlrev_b32 v3, 2, v2
  s_lshl_b32 s14, s7, 9
  s_bfe_u32 s15, s5, 0x10001
  s_lshl_b32 s15, s15, 8
  s_add_u32 s14, s14, s15
  v_add_u32 v3, s14, v3
  s_lshl_b32 s14, s7, 1
  v_mov_b32 v4, s14
  s_lshl_b32 s72, s5, 8
  s_waitcnt lgkmcnt(0)
  global_load_dword v10, v3, s[22:23]
  global_load_dword v11, v3, s[24:25]
  global_load_short_d16_hi v16, v4, s[26:27]
  global_load_dword v8, v3, s[18:19]
  global_load_dword v9, v3, s[20:21]
  global_load_short_d16_hi v17, v4, s[28:29]
L_g_dec:
  s_lshr_b32 s6, s3, 1
  s_lshl_b32 s6, s6, 2
  s_and_b32 s60, s3, 1
  s_lshr_b32 s8, s4, 2
  s_add_u32 s8, s8, s6
  s_and_b32 s9, s4, 3
  s_lshl_b32 s10, s60, 2
  s_add_u32 s9, s9, s10
  s_mul_i32 s10, s9, 112
  s_add_u32 s11, s10, 1792
  s_add_u32 s10, s10, 896
  s_sub_u32 s12, s4, 16
  s_lshr_b32 s61, s12, 1
  s_add_u32 s61, s61, s6
  s_and_b32 s12, s12, 1
  s_lshl_b32 s14, s60, 1
  s_add_u32 s12, s12, s14
  s_mul_i32 s14, s12, 224
  s_add_u32 s15, s14, 112
  s_cmp_lt_u32 s4, 16
  s_cselect_b32 s8, s8, s61
  s_cselect_b32 s9, s9, s12
  s_cselect_b32 s10, s10, s14
  s_cselect_b32 s11, s11, s15
  s_and_b32 s60, s5, 3
  v_lshrrev_b32 v164, 3, v2
  v_lshrrev_b32 v165, 4, v2
  v_and_b32 v166, 7, v2
  s_lshl_b32 s12, s8, 7
  s_lshl_b32 s61, s60, 5
  s_add_u32 s12, s12, s61
  v_add_u32 v167, s12, v164
  v_mul_u32_u24 v167, 896, v167
  v_xor_b32 v168, v166, v165
  v_lshl_add_u32 v128, v168, 4, v167
  v_xor_b32 v168, 4, v168
  v_lshl_add_u32 v129, v168, 4, v167
  v_add_u32 v129, 7168, v129
  s_lshl_b32 s61, s60, 4
  v_add_u32 v167, s61, v164
  v_mul_u32_u24 v167, 2688, v167
  v_and_b32 v168, 1, v165
  v_lshlrev_b32 v168, 2, v168
  v_xor_b32 v168, v168, v166
  v_lshl_add_u32 v167, v168, 4, v167
  v_add_u32 v130, s10, v167
  v_add_u32 v131, s11, v167
  s_lshl_b32 s10, s60, 12
  s_lshl_b32 s11, s60, 11
  s_add_u32 s11, s11, 16384
  s_waitcnt lgkmcnt(0)
  s_mov_b32 s44, s30
  s_mov_b32 s45, s31
  s_mov_b32 s46, 0x1c0000
  s_mov_b32 s47, 0x20000
  s_mov_b32 s48, s32
  s_mov_b32 s49, s33
  s_mov_b32 s50, 0x126000
  s_mov_b32 s51, 0x20000
  s_and_b32 s73, s8, 3
  s_lshl_b32 s73, s73, 1
  s_and_b32 s61, s9, 3
  s_and_b32 s62, s9, 1
  s_add_u32 s62, s62, 4
  s_cmp_lt_u32 s4, 16
  s_cselect_b32 s61, s61, s62
  s_add_u32 s73, s73, s61
  s_sub_u32 s61, s73, 7
  s_cmp_ge_u32 s73, 7
  s_cselect_b32 s73, s61, s73
  s_mov_b32 s73, 0
  s_cmp_lt_u32 s5, 4
  s_cbranch_scc1 Lo_1
  s_lshl_b32 s6, s73, 7
  s_mul_i32 s12, s73, 172032
  s_add_u32 s73, s73, 1
  s_cmp_eq_u32 s73, 7
  s_cselect_b32 s73, 0, s73
  s_add_u32 m0, s10, 21760
  s_nop 0
  buffer_load_dwordx4 v128, s[44:47], s6 offen lds
  s_add_u32 m0, s11, 21760
  s_nop 0
  buffer_load_dwordx4 v130, s[48:51], s12 offen lds
  s_add_u32 m0, s10, 22784
  s_nop 0
  buffer_load_dwordx4 v129, s[44:47], s6 offen lds
  s_add_u32 m0, s11, 29952
  s_nop 0
  buffer_load_dwordx4 v131, s[48:51], s12 offen lds
  s_add_u32 s6, s6, 14336
  s_add_u32 s12, s12, 21504
  s_add_u32 m0, s10, 23808
  s_nop 0
  buffer_load_dwordx4 v128, s[44:47], s6 offen lds
  s_add_u32 m0, s11, 22784
  s_nop 0
  buffer_load_dwordx4 v130, s[48:51], s12 offen lds
  s_add_u32 m0, s10, 24832
  s_nop 0
  buffer_load_dwordx4 v129, s[44:47], s6 offen lds
  s_add_u32 m0, s11, 30976
  s_nop 0
  buffer_load_dwordx4 v131, s[48:51], s12 offen lds
  s_lshl_b32 s6, s73, 7
  s_mul_i32 s12, s73, 172032
  s_add_u32 s73, s73, 1
  s_cmp_eq_u32 s73, 7
  s_cselect_b32 s73, 0, s73
  s_add_u32 m0, s10, 54528
  s_nop 0
  buffer_load_dwordx4 v128, s[44:47], s6 offen lds
  s_add_u32 m0, s11, 54528
  s_nop 0
  buffer_load_dwordx4 v130, s[48:51], s12 offen lds
  s_add_u32 m0, s10, 55552
  s_nop 0
  buffer_load_dwordx4 v129, s[44:47], s6 offen lds
  s_add_u32 m0, s11, 62720
  s_nop 0
  buffer_load_dwordx4 v131, s[48:51], s12 offen lds
  s_add_u32 s6, s6, 14336
  s_add_u32 s12, s12, 21504
  s_add_u32 m0, s10, 56576
  s_nop 0
  buffer_load_dwordx4 v128, s[44:47], s6 offen lds
  s_add_u32 m0, s11, 55552
  s_nop 0
  buffer_load_dwordx4 v130, s[48:51], s12 offen lds
  s_add_u32 m0, s10, 57600
  s_nop 0
  buffer_load_dwordx4 v129, s[44:47], s6 offen lds
  s_add_u32 m0, s11, 63744
  s_nop 0
  buffer_load_dwordx4 v131, s[48:51], s12 offen lds
  s_lshl_b32 s6, s73, 7
  s_mul_i32 s12, s73, 172032
  s_add_u32 s73, s73, 1
  s_cmp_eq_u32 s73, 7
  s_cselect_b32 s73, 0, s73
  s_add_u32 m0, s10, 87296
  s_nop 0
  buffer_load_dwordx4 v128, s[44:47], s6 offen lds
  s_add_u32 m0, s11, 87296
  s_nop 0
  buffer_load_dwordx4 v130, s[48:51], s12 offen lds
  s_add_u32 m0, s10, 88320
  s_nop 0
  buffer_load_dwordx4 v129, s[44:47], s6 offen lds
  s_add_u32 m0, s11, 95488
  s_nop 0
  buffer_load_dwordx4 v131, s[48:51], s12 offen lds
  s_add_u32 s6, s6, 14336
  s_add_u32 s12, s12, 21504
  s_add_u32 m0, s10, 89344
  s_nop 0
  buffer_load_dwordx4 v128, s[44:47], s6 offen lds
  s_add_u32 m0, s11, 88320
  s_nop 0
  buffer_load_dwordx4 v130, s[48:51], s12 offen lds
  s_add_u32 m0, s10, 90368
  s_nop 0
  buffer_load_dwordx4 v129, s[44:47], s6 offen lds
  s_add_u32 m0, s11, 96512
  s_nop 0
  buffer_load_dwordx4 v131, s[48:51], s12 offen lds
  s_waitcnt vmcnt(16)
  s_lshl_b32 s6, s73, 7
  s_mul_i32 s12, s73, 172032
  s_add_u32 s73, s73, 1
  s_cmp_eq_u32 s73, 7
  s_cselect_b32 s73, 0, s73
  s_add_u32 m0, s10, 120064
  s_nop 0
  buffer_load_dwordx4 v128, s[44:47], s6 offen lds
  s_add_u32 m0, s11, 120064
  s_nop 0
  buffer_load_dwordx4 v130, s[48:51], s12 offen lds
  s_add_u32 m0, s10, 121088
  s_nop 0
  buffer_load_dwordx4 v129, s[44:47], s6 offen lds
  s_add_u32 m0, s11, 128256
  s_nop 0
  buffer_load_dwordx4 v131, s[48:51], s12 offen lds
  s_add_u32 s6, s6, 14336
  s_add_u32 s12, s12, 21504
  s_add_u32 m0, s10, 122112
  s_nop 0
  buffer_load_dwordx4 v128, s[44:47], s6 offen lds
  s_add_u32 m0, s11, 121088
  s_nop 0
  buffer_load_dwordx4 v130, s[48:51], s12 offen lds
  s_add_u32 m0, s10, 123136
  s_nop 0
  buffer_load_dwordx4 v129, s[44:47], s6 offen lds
  s_add_u32 m0, s11, 129280
  s_nop 0
  buffer_load_dwordx4 v131, s[48:51], s12 offen lds
Lo_1:
  s_cmp_ge_u32 s5, 4
  s_cbranch_scc1 Lo_2
  s_add_u32 s73, s73, 4
  s_sub_u32 s61, s73, 7
  s_cmp_ge_u32 s73, 7
  s_cselect_b32 s73, s61, s73
Lo_2:
  s_mul_i32 s42, s65, 14336
  s_mul_i32 s43, s65, 21504
  s_lshl_b32 s61, s65, 11
  s_add_u32 s10, s10, s61
  s_lshl_b32 s61, s65, 10
  s_add_u32 s11, s11, s61
  v_and_b32 v164, 31, v2
  v_lshrrev_b32 v165, 5, v2
  v_bfe_u32 v166, v2, 1, 3
  v_xor_b32 v166, v166, v165
  s_lshl_b32 s15, s60, 12
  v_lshlrev_b32 v164, 7, v164
  v_lshl_add_u32 v164, v166, 4, v164
  v_add_u32 v132, s15, v164
  v_xor_b32 v133, 32, v132
  v_xor_b32 v134, 64, v132
  v_xor_b32 v135, 0x60, v132
  s_mul_i32 s15, s65, 56
  v_bfe_u32 v164, v2, 4, 1
  v_lshlrev_b32 v164, 5, v164
  v_and_b32 v166, 3, v2
  v_lshl_add_u32 v164, v166, 3, v164
  v_add_u32 v164, s15, v164
  v_bfe_u32 v166, v2, 3, 1
  v_lshlrev_b32 v166, 6, v166
  v_xor_b32 v164, v164, v166
  v_bfe_u32 v166, v2, 2, 2
  v_lshl_add_u32 v166, v165, 3, v166
  v_lshl_add_u32 v164, v166, 7, v164
  v_add_u32 v136, 16384, v164
  v_add_u32 v140, 0x10000, v132
  v_add_u32 v148, 0x20000, v132
  v_add_u32 v141, 0x10000, v133
  v_add_u32 v149, 0x20000, v133
  v_add_u32 v142, 0x10000, v134
  v_add_u32 v150, 0x20000, v134
  v_add_u32 v143, 0x10000, v135
  v_add_u32 v151, 0x20000, v135
  v_add_u32 v144, 0x10000, v136
  v_add_u32 v152, 0x20000, v136
  v_lshlrev_b32 v138, 2, v2
  v_and_b32 v146, 28, v138
  s_add_u32 s52, s40, 0x210000
  s_addc_u32 s53, s41, 0
  s_mov_b32 s54, 0x1ce000
  s_mov_b32 s55, 0x20000
  v_lshlrev_b32 v26, 4, v2
  s_add_u32 s56, s40, 0x800000
  s_addc_u32 s57, s41, 0
  s_mov_b32 s58, 0x8000
  s_mov_b32 s59, 0x20000
  s_mov_b32 s60, s38
  s_mov_b32 s61, s39
  s_mov_b32 s62, 0x100
  s_mov_b32 s63, 0x20000
  s_cmp_ge_u32 s5, 4
  s_cbranch_scc1 Lo_3
  s_movk_i32 s13, 16912
  s_mov_b32 s66, 0x3fb8aa3b
  s_mov_b32 s67, 0xbfb8aa3b
  s_mov_b32 s68, 0x3e22f983
  s_mov_b32 s69, 0x31dc9c88
  s_mov_b32 s70, 0x41000000
  s_mov_b32 s71, 0x43800000
  v_and_b32 v24, 15, v2
  v_mul_u32_u24 v20, 1056, v24
  v_lshrrev_b32 v21, 4, v2
  v_lshl_add_u32 v20, v21, 4, v20
  v_add_u32 v20, s72, v20
  v_mul_u32_u24 v21, 1056, v21
  v_lshl_add_u32 v21, v24, 4, v21
  v_mov_b32 v22, 0x00003c00
  s_add_u32 s52, s40, 0x210000
  s_addc_u32 s53, s41, 0
  s_mov_b32 s54, 0x1ce000
  s_mov_b32 s55, 0x20000
  v_lshl_add_u32 v24, v24, 4, s13
  s_mov_b32 exec_lo, 0xffff
  s_mov_b32 exec_hi, 0x0
  v_add_u32 v3, 0, v24
  v_add_u32 v4, 2, v24
  v_add_u32 v5, 4, v24
  v_add_u32 v6, 6, v24
  v_add_u32 v7, 2048, v24
  v_add_u32 v14, 2560, v24
  v_add_u32 v15, 3072, v24
  v_add_u32 v18, 3584, v24
  s_mov_b32 exec_lo, 0xffff0000
  s_mov_b32 exec_hi, 0x0
  v_add_u32 v3, 8, v24
  v_add_u32 v4, 10, v24
  v_add_u32 v5, 12, v24
  v_add_u32 v6, 14, v24
  v_add_u32 v7, 4096, v24
  v_add_u32 v14, 4098, v24
  v_add_u32 v15, 4098, v24
  v_add_u32 v18, 4098, v24
  s_mov_b32 exec_lo, 0x0
  s_mov_b32 exec_hi, 0xffff
  v_add_u32 v3, 512, v24
  v_add_u32 v4, 516, v24
  v_add_u32 v5, 520, v24
  v_add_u32 v6, 524, v24
  v_add_u32 v7, 4098, v24
  v_add_u32 v14, 4098, v24
  v_add_u32 v15, 4098, v24
  v_add_u32 v18, 4098, v24
  s_mov_b32 exec_lo, 0x0
  s_mov_b32 exec_hi, 0xffff0000
  v_add_u32 v3, 1024, v24
  v_add_u32 v4, 1032, v24
  v_add_u32 v5, 1536, v24
  v_add_u32 v6, 1544, v24
  v_add_u32 v7, 4098, v24
  v_add_u32 v14, 4098, v24
  v_add_u32 v15, 4098, v24
  v_add_u32 v18, 4098, v24
  s_mov_b64 exec, -1
  s_mov_b32 m0, s72
  s_waitcnt vmcnt(3)
  v_and_b32 v24, 0x7fff7fff, v10
  v_and_b32 v25, 0x7fff7fff, v11
  v_and_b32 v16, 0xffff0000, v16
  v_pk_max_u16 v24, v24, v25
  v_mul_f32 v16, s66, v16
  v_exp_f32 v16, v16
  v_lshrrev_b32 v25, 16, v24
  v_and_b32 v24, 0xffff, v24
  v_max_u32 v24, v24, v25
  v_cvt_pk_bf16_f32 v16, v16, v16
  v_and_b32 v16, 0xffff0000, v16
  v_max_u32_dpp v24, v24, v24 row_shr:1 row_mask:0xf bank_mask:0xf
  s_nop 1
  v_max_u32_dpp v24, v24, v24 row_shr:2 row_mask:0xf bank_mask:0xf
  s_nop 1
  v_max_u32_dpp v24, v24, v24 row_shr:4 row_mask:0xf bank_mask:0xf
  s_nop 1
  v_max_u32_dpp v24, v24, v24 row_shr:8 row_mask:0xf bank_mask:0xf
  s_nop 1
  v_max_u32_dpp v24, v24, v24 row_bcast:15 row_mask:0xa bank_mask:0xf
  s_nop 1
  v_max_u32_dpp v24, v24, v24 row_bcast:31 row_mask:0xc bank_mask:0xf
  s_nop 1
  v_readlane_b32 s74, v24, 63
  v_readfirstlane_b32 s75, v16
  s_nop 3
  s_lshr_b32 s74, s74, 7
  s_max_u32 s74, s74, 14
  s_min_u32 s74, s74, 254
  s_sub_u32 s76, 267, s74
  s_lshl_b32 s76, s76, 23
  s_sub_u32 s77, s74, 13
  s_lshl_b32 s77, s77, 23
  s_waitcnt vmcnt(0)
  s_bitcmp0_b32 s5, 0
  s_cbranch_scc1 Lsh_4
  v_lshrrev_b32 v8, 16, v8
  v_lshrrev_b32 v9, 16, v9
  v_lshrrev_b32 v10, 16, v10
  v_lshrrev_b32 v11, 16, v11
Lsh_4:
  v_lshlrev_b32 v24, 16, v8
  v_lshlrev_b32 v25, 16, v9
  v_mul_f32 v24, s66, v24
  v_exp_f32 v24, v24
  v_mul_f32 v25, s75, v25
  v_mul_f32 v26, s68, v25
  v_cvt_pk_bf16_f32 v24, v24, v24
  v_fma_f32 v27, v25, s68, -v26
  v_and_b32 v24, 0xffff0000, v24
  v_fmac_f32 v27, s69, v25
  v_mul_f32 v24, s75, v24
  v_mul_f32 v24, s67, v24
  v_lshlrev_b32 v54, 16, v10
  v_lshlrev_b32 v55, 16, v11
  v_mul_f32 v54, s76, v54
  v_mul_f32 v55, s76, v55
  v_exp_f32 v28, v24
  v_mul_f32 v74, s70, v24
  v_mul_f32 v77, s71, v24
  v_fract_f32 v29, v26
  v_exp_f32 v74, v74
  v_exp_f32 v77, v77
  v_add_f32 v29, v29, v27
  v_mul_f32 v75, s70, v26
  v_mul_f32 v78, s71, v26
  v_cos_f32 v30, v29
  v_fract_f32 v75, v75
  v_fract_f32 v78, v78
  v_sin_f32 v29, v29
  v_fmac_f32 v75, s70, v27
  v_fmac_f32 v78, s71, v27
  s_nop 0
  v_cos_f32 v76, v75
  v_cos_f32 v79, v78
  v_mul_f32 v32, v28, v30
  v_sin_f32 v75, v75
  v_sin_f32 v78, v78
  v_mul_f32_e64 v33, v28, v29
  s_nop 0
  s_nop 0
  v_mul_f32 v40, v74, v76
  v_mul_f32 v38, v77, v79
  v_mul_f32_e64 v41, v74, -v75
  v_mul_f32_e64 v39, v77, v78
  v_pk_mul_f32 v[58:59], v[54:55], v[38:39] op_sel:[0,0] op_sel_hi:[1,0]
  v_pk_fma_f32 v[58:59], v[54:55], v[38:39], v[58:59] op_sel:[1,1,0] op_sel_hi:[0,1,1] neg_lo:[1,0,0]
  v_cvt_pk_f16_f32 v74, v54, v55
  v_pk_mul_f32 v[34:35], v[32:33], v[32:33] op_sel:[0,0] op_sel_hi:[1,0]
  v_cvt_pk_f16_f32 v64, v40, v41
  ds_write_addtid_b32 v74 offset:0
  v_pk_fma_f32 v[34:35], v[32:33], v[32:33], v[34:35] op_sel:[1,1,0] op_sel_hi:[0,1,1] neg_lo:[1,0,0]
  v_pk_mul_f32 v[42:43], v[40:41], v[40:41] op_sel:[0,0] op_sel_hi:[1,0]
  v_pk_mul_f32 v[56:57], v[54:55], v[32:33] op_sel:[0,0] op_sel_hi:[1,0]
  v_pk_mul_f32 v[36:37], v[34:35], v[34:35] op_sel:[0,0] op_sel_hi:[1,0]
  v_pk_fma_f32 v[42:43], v[40:41], v[40:41], v[42:43] op_sel:[1,1,0] op_sel_hi:[0,1,1] neg_lo:[1,0,0]
  v_pk_fma_f32 v[56:57], v[54:55], v[32:33], v[56:57] op_sel:[1,1,0] op_sel_hi:[0,1,1] neg_lo:[1,0,0]
  v_pk_fma_f32 v[36:37], v[34:35], v[34:35], v[36:37] op_sel:[1,1,0] op_sel_hi:[0,1,1] neg_lo:[1,0,0]
  v_cvt_pk_f16_f32 v65, v42, v43
  v_cvt_pk_f16_f32 v75, v56, v57
  v_cvt_pk_f16_f32 v76, v58, v59
  v_pk_mul_f32 v[46:47], v[42:43], v[42:43] op_sel:[0,0] op_sel_hi:[1,0]
  ds_write_addtid_b32 v75 offset:1056
  ds_write_addtid_b32 v76 offset:8448
  v_pk_fma_f32 v[46:47], v[42:43], v[42:43], v[46:47] op_sel:[1,1,0] op_sel_hi:[0,1,1] neg_lo:[1,0,0]
  v_pk_mul_f32 v[54:55], v[56:57], v[32:33] op_sel:[0,0] op_sel_hi:[1,0]
  v_pk_mul_f32 v[60:61], v[58:59], v[38:39] op_sel:[0,0] op_sel_hi:[1,0]
  v_pk_mul_f32 v[44:45], v[42:43], v[40:41] op_sel:[0,0] op_sel_hi:[1,0]
  v_pk_fma_f32 v[54:55], v[56:57], v[32:33], v[54:55] op_sel:[1,1,0] op_sel_hi:[0,1,1] neg_lo:[1,0,0]
  v_pk_fma_f32 v[60:61], v[58:59], v[38:39], v[60:61] op_sel:[1,1,0] op_sel_hi:[0,1,1] neg_lo:[1,0,0]
  v_pk_fma_f32 v[44:45], v[42:43], v[40:41], v[44:45] op_sel:[1,1,0] op_sel_hi:[0,1,1] neg_lo:[1,0,0]
  v_cvt_pk_f16_f32 v156, v54, v55
  v_pk_mul_f32 v[62:63], v[58:59], v[34:35] op_sel:[0,0] op_sel_hi:[1,0]
  v_cvt_pk_f16_f32 v67, v46, v47
  ds_write_addtid_b32 v156 offset:2112
  v_pk_fma_f32 v[62:63], v[58:59], v[34:35], v[62:63] op_sel:[1,1,0] op_sel_hi:[0,1,1] neg_lo:[1,0,0]
  v_cvt_pk_f16_f32 v66, v44, v45
  v_pk_mul_f32 v[56:57], v[54:55], v[32:33] op_sel:[0,0] op_sel_hi:[1,0]
  v_cvt_pk_f16_f32 v77, v62, v63
  v_pk_mul_f32 v[50:51], v[46:47], v[46:47] op_sel:[0,0] op_sel_hi:[1,0]
  v_pk_fma_f32 v[56:57], v[54:55], v[32:33], v[56:57] op_sel:[1,1,0] op_sel_hi:[0,1,1] neg_lo:[1,0,0]
  ds_write_addtid_b32 v77 offset:9504
  v_pk_fma_f32 v[50:51], v[46:47], v[46:47], v[50:51] op_sel:[1,1,0] op_sel_hi:[0,1,1] neg_lo:[1,0,0]
  v_cvt_pk_f16_f32 v157, v56, v57
  v_pk_mul_f32 v[12:13], v[58:59], v[36:37] op_sel:[0,0] op_sel_hi:[1,0]
  v_pk_mul_f32 v[48:49], v[46:47], v[40:41] op_sel:[0,0] op_sel_hi:[1,0]
  ds_write_addtid_b32 v157 offset:3168
  v_pk_fma_f32 v[12:13], v[58:59], v[36:37], v[12:13] op_sel:[1,1,0] op_sel_hi:[0,1,1] neg_lo:[1,0,0]
  v_pk_fma_f32 v[48:49], v[46:47], v[40:41], v[48:49] op_sel:[1,1,0] op_sel_hi:[0,1,1] neg_lo:[1,0,0]
  v_pk_mul_f32 v[54:55], v[56:57], v[32:33] op_sel:[0,0] op_sel_hi:[1,0]
  v_cvt_pk_f16_f32 v158, v12, v13
  v_cvt_pk_f16_f32 v68, v48, v49
  v_pk_fma_f32 v[54:55], v[56:57], v[32:33], v[54:55] op_sel:[1,1,0] op_sel_hi:[0,1,1] neg_lo:[1,0,0]
  ds_write_addtid_b32 v158 offset:10560
  v_pk_mul_f32 v[52:53], v[50:51], v[50:51] op_sel:[0,0] op_sel_hi:[1,0]
  v_cvt_pk_f16_f32 v74, v54, v55
  v_pk_mul_f32 v[62:63], v[12:13], v[34:35] op_sel:[0,0] op_sel_hi:[1,0]
  v_pk_fma_f32 v[52:53], v[50:51], v[50:51], v[52:53] op_sel:[1,1,0] op_sel_hi:[0,1,1] neg_lo:[1,0,0]
  ds_write_addtid_b32 v74 offset:4224
  v_pk_fma_f32 v[62:63], v[12:13], v[34:35], v[62:63] op_sel:[1,1,0] op_sel_hi:[0,1,1] neg_lo:[1,0,0]
  v_pk_mul_f32 v[48:49], v[46:47], v[42:43] op_sel:[0,0] op_sel_hi:[1,0]
  v_pk_mul_f32 v[56:57], v[54:55], v[32:33] op_sel:[0,0] op_sel_hi:[1,0]
  v_cvt_pk_f16_f32 v159, v62, v63
  v_pk_fma_f32 v[48:49], v[46:47], v[42:43], v[48:49] op_sel:[1,1,0] op_sel_hi:[0,1,1] neg_lo:[1,0,0]
  v_pk_fma_f32 v[56:57], v[54:55], v[32:33], v[56:57] op_sel:[1,1,0] op_sel_hi:[0,1,1] neg_lo:[1,0,0]
  ds_write_addtid_b32 v159 offset:11616
  v_cvt_pk_f16_f32 v69, v48, v49
  v_cvt_pk_f16_f32 v75, v56, v57
  v_cvt_pk_f16_f32 v76, v60, v61
  v_pk_mul_f32 v[48:49], v[46:47], v[44:45] op_sel:[0,0] op_sel_hi:[1,0]
  ds_write_addtid_b32 v75 offset:5280
  ds_write_addtid_b32 v76 offset:12672
  v_pk_fma_f32 v[48:49], v[46:47], v[44:45], v[48:49] op_sel:[1,1,0] op_sel_hi:[0,1,1] neg_lo:[1,0,0]
  v_pk_mul_f32 v[54:55], v[56:57], v[32:33] op_sel:[0,0] op_sel_hi:[1,0]
  v_pk_mul_f32 v[58:59], v[60:61], v[38:39] op_sel:[0,0] op_sel_hi:[1,0]
  v_cvt_pk_f16_f32 v70, v48, v49
  v_pk_fma_f32 v[54:55], v[56:57], v[32:33], v[54:55] op_sel:[1,1,0] op_sel_hi:[0,1,1] neg_lo:[1,0,0]
  v_pk_fma_f32 v[58:59], v[60:61], v[38:39], v[58:59] op_sel:[1,1,0] op_sel_hi:[0,1,1] neg_lo:[1,0,0]
  v_pk_mul_f32 v[48:49], v[52:53], v[50:51] op_sel:[0,0] op_sel_hi:[1,0]
  v_cvt_pk_f16_f32 v156, v54, v55
  v_pk_mul_f32 v[62:63], v[60:61], v[36:37] op_sel:[0,0] op_sel_hi:[1,0]
  v_pk_fma_f32 v[48:49], v[52:53], v[50:51], v[48:49] op_sel:[1,1,0] op_sel_hi:[0,1,1] neg_lo:[1,0,0]
  ds_write_addtid_b32 v156 offset:6336
  v_pk_fma_f32 v[62:63], v[60:61], v[36:37], v[62:63] op_sel:[1,1,0] op_sel_hi:[0,1,1] neg_lo:[1,0,0]
  v_cvt_pk_f16_f32 v71, v50, v51
  v_pk_mul_f32 v[56:57], v[54:55], v[32:33] op_sel:[0,0] op_sel_hi:[1,0]
  v_cvt_pk_f16_f32 v77, v62, v63
  v_cvt_pk_f16_f32 v72, v52, v53
  v_pk_fma_f32 v[56:57], v[54:55], v[32:33], v[56:57] op_sel:[1,1,0] op_sel_hi:[0,1,1] neg_lo:[1,0,0]
  ds_write_addtid_b32 v77 offset:13728
  v_cvt_pk_f16_f32 v73, v48, v49
  v_cvt_pk_f16_f32 v157, v56, v57
  v_cvt_pk_f16_f32 v158, v58, v59
  ds_write_addtid_b32 v157 offset:7392
  ds_write_addtid_b32 v158 offset:14784
  v_pk_mul_f32 v[60:61], v[58:59], v[38:39] op_sel:[0,0] op_sel_hi:[1,0]
  v_pk_fma_f32 v[60:61], v[58:59], v[38:39], v[60:61] op_sel:[1,1,0] op_sel_hi:[0,1,1] neg_lo:[1,0,0]
  v_pk_mul_f32 v[62:63], v[58:59], v[36:37] op_sel:[0,0] op_sel_hi:[1,0]
  v_pk_fma_f32 v[62:63], v[58:59], v[36:37], v[62:63] op_sel:[1,1,0] op_sel_hi:[0,1,1] neg_lo:[1,0,0]
  v_cvt_pk_f16_f32 v159, v62, v63
  ds_write_addtid_b32 v159 offset:15840
  ds_read_b128 v[80:83], v20 offset:0
  ds_read_b128 v[84:87], v20 offset:64
  ds_read_b128 v[88:91], v20 offset:128
  ds_read_b128 v[92:95], v20 offset:192
  v_cvt_pk_f16_f32 v76, v60, v61
  v_pk_mul_f16 v32, v71, v64 op_sel:[0,0] op_sel_hi:[1,0]
  ds_write_addtid_b32 v76 offset:0
  v_pk_fma_f16 v32, v71, v64, v32 op_sel:[1,1,0] op_sel_hi:[0,1,1] neg_lo:[1,0,0]
  v_pk_mul_f32 v[58:59], v[60:61], v[38:39] op_sel:[0,0] op_sel_hi:[1,0]
  v_pk_mul_f16 v33, v71, v65 op_sel:[0,0] op_sel_hi:[1,0]
  v_pk_fma_f32 v[58:59], v[60:61], v[38:39], v[58:59] op_sel:[1,1,0] op_sel_hi:[0,1,1] neg_lo:[1,0,0]
  v_pk_fma_f16 v33, v71, v65, v33 op_sel:[1,1,0] op_sel_hi:[0,1,1] neg_lo:[1,0,0]
  v_cvt_pk_f16_f32 v77, v58, v59
  v_pk_mul_f16 v34, v71, v66 op_sel:[0,0] op_sel_hi:[1,0]
  ds_write_addtid_b32 v77 offset:1056
  v_pk_fma_f16 v34, v71, v66, v34 op_sel:[1,1,0] op_sel_hi:[0,1,1] neg_lo:[1,0,0]
  v_pk_mul_f32 v[60:61], v[58:59], v[38:39] op_sel:[0,0] op_sel_hi:[1,0]
  v_pk_mul_f16 v35, v71, v67 op_sel:[0,0] op_sel_hi:[1,0]
  v_pk_fma_f32 v[60:61], v[58:59], v[38:39], v[60:61] op_sel:[1,1,0] op_sel_hi:[0,1,1] neg_lo:[1,0,0]
  v_pk_fma_f16 v35, v71, v67, v35 op_sel:[1,1,0] op_sel_hi:[0,1,1] neg_lo:[1,0,0]
  v_cvt_pk_f16_f32 v158, v60, v61
  v_pk_mul_f16 v36, v71, v68 op_sel:[0,0] op_sel_hi:[1,0]
  ds_write_addtid_b32 v158 offset:2112
  v_pk_fma_f16 v36, v71, v68, v36 op_sel:[1,1,0] op_sel_hi:[0,1,1] neg_lo:[1,0,0]
  v_pk_mul_f32 v[58:59], v[60:61], v[38:39] op_sel:[0,0] op_sel_hi:[1,0]
  v_pk_mul_f16 v37, v71, v69 op_sel:[0,0] op_sel_hi:[1,0]
  v_pk_fma_f32 v[58:59], v[60:61], v[38:39], v[58:59] op_sel:[1,1,0] op_sel_hi:[0,1,1] neg_lo:[1,0,0]
  v_pk_fma_f16 v37, v71, v69, v37 op_sel:[1,1,0] op_sel_hi:[0,1,1] neg_lo:[1,0,0]
  v_cvt_pk_f16_f32 v159, v58, v59
  v_pk_mul_f16 v40, v71, v70 op_sel:[0,0] op_sel_hi:[1,0]
  ds_write_addtid_b32 v159 offset:3168
  v_pk_fma_f16 v40, v71, v70, v40 op_sel:[1,1,0] op_sel_hi:[0,1,1] neg_lo:[1,0,0]
  v_pk_mul_f32 v[60:61], v[58:59], v[38:39] op_sel:[0,0] op_sel_hi:[1,0]
  v_pk_fma_f32 v[60:61], v[58:59], v[38:39], v[60:61] op_sel:[1,1,0] op_sel_hi:[0,1,1] neg_lo:[1,0,0]
  v_cvt_pk_f16_f32 v76, v60, v61
  ds_write_addtid_b32 v76 offset:4224
  ds_read_b128 v[96:99], v20 offset:0
  ds_read_b128 v[100:103], v20 offset:64
  ds_read_b128 v[104:107], v20 offset:128
  ds_read_b128 v[108:111], v20 offset:192
  ds_write_addtid_b32 v22 offset:0
  v_pk_mul_f16 v41, v72, v64 op_sel:[0,0] op_sel_hi:[1,0]
  ds_write_addtid_b32 v64 offset:1056
  v_pk_fma_f16 v41, v72, v64, v41 op_sel:[1,1,0] op_sel_hi:[0,1,1] neg_lo:[1,0,0]
  ds_write_addtid_b32 v65 offset:2112
  v_pk_mul_f16 v42, v72, v65 op_sel:[0,0] op_sel_hi:[1,0]
  ds_write_addtid_b32 v66 offset:3168
  v_pk_fma_f16 v42, v72, v65, v42 op_sel:[1,1,0] op_sel_hi:[0,1,1] neg_lo:[1,0,0]
  ds_write_addtid_b32 v67 offset:4224
  v_pk_mul_f16 v43, v72, v66 op_sel:[0,0] op_sel_hi:[1,0]
  ds_write_addtid_b32 v68 offset:5280
  v_pk_fma_f16 v43, v72, v66, v43 op_sel:[1,1,0] op_sel_hi:[0,1,1] neg_lo:[1,0,0]
  ds_write_addtid_b32 v69 offset:6336
  v_pk_mul_f16 v44, v72, v67 op_sel:[0,0] op_sel_hi:[1,0]
  ds_write_addtid_b32 v70 offset:7392
  v_pk_fma_f16 v44, v72, v67, v44 op_sel:[1,1,0] op_sel_hi:[0,1,1] neg_lo:[1,0,0]
  ds_write_addtid_b32 v71 offset:8448
  v_pk_mul_f16 v45, v72, v68 op_sel:[0,0] op_sel_hi:[1,0]
  ds_write_addtid_b32 v32 offset:9504
  v_pk_fma_f16 v45, v72, v68, v45 op_sel:[1,1,0] op_sel_hi:[0,1,1] neg_lo:[1,0,0]
  ds_write_addtid_b32 v33 offset:10560
  v_pk_mul_f16 v46, v72, v69 op_sel:[0,0] op_sel_hi:[1,0]
  ds_write_addtid_b32 v34 offset:11616
  v_pk_fma_f16 v46, v72, v69, v46 op_sel:[1,1,0] op_sel_hi:[0,1,1] neg_lo:[1,0,0]
  ds_write_addtid_b32 v35 offset:12672
  v_pk_mul_f16 v47, v72, v70 op_sel:[0,0] op_sel_hi:[1,0]
  ds_write_addtid_b32 v36 offset:13728
  v_pk_fma_f16 v47, v72, v70, v47 op_sel:[1,1,0] op_sel_hi:[0,1,1] neg_lo:[1,0,0]
  ds_write_addtid_b32 v37 offset:14784
  ds_write_addtid_b32 v40 offset:15840
  ds_read_b128 v[48:51], v20 offset:0
  ds_read_b128 v[52:55], v20 offset:64
  ds_read_b128 v[56:59], v20 offset:128
  ds_read_b128 v[60:63], v20 offset:192
  ds_write_addtid_b32 v72 offset:0
  v_pk_mul_f16 v75, v73, v64 op_sel:[0,0] op_sel_hi:[1,0]
  ds_write_addtid_b32 v41 offset:1056
  v_pk_fma_f16 v75, v73, v64, v75 op_sel:[1,1,0] op_sel_hi:[0,1,1] neg_lo:[1,0,0]
  ds_write_addtid_b32 v42 offset:2112
  ds_write_addtid_b32 v75 offset:9504
  ds_write_addtid_b32 v43 offset:3168
  v_pk_mul_f16 v156, v73, v65 op_sel:[0,0] op_sel_hi:[1,0]
  ds_write_addtid_b32 v44 offset:4224
  v_pk_fma_f16 v156, v73, v65, v156 op_sel:[1,1,0] op_sel_hi:[0,1,1] neg_lo:[1,0,0]
  ds_write_addtid_b32 v45 offset:5280
  ds_write_addtid_b32 v156 offset:10560
  ds_write_addtid_b32 v46 offset:6336
  v_pk_mul_f16 v157, v73, v66 op_sel:[0,0] op_sel_hi:[1,0]
  ds_write_addtid_b32 v47 offset:7392
  v_pk_fma_f16 v157, v73, v66, v157 op_sel:[1,1,0] op_sel_hi:[0,1,1] neg_lo:[1,0,0]
  ds_write_addtid_b32 v73 offset:8448
  ds_write_addtid_b32 v157 offset:11616
  v_pk_mul_f16 v74, v73, v67 op_sel:[0,0] op_sel_hi:[1,0]
  v_pk_fma_f16 v74, v73, v67, v74 op_sel:[1,1,0] op_sel_hi:[0,1,1] neg_lo:[1,0,0]
  ds_write_addtid_b32 v74 offset:12672
  v_pk_mul_f16 v75, v73, v68 op_sel:[0,0] op_sel_hi:[1,0]
  v_pk_fma_f16 v75, v73, v68, v75 op_sel:[1,1,0] op_sel_hi:[0,1,1] neg_lo:[1,0,0]
  ds_write_addtid_b32 v75 offset:13728
  v_pk_mul_f16 v156, v73, v69 op_sel:[0,0] op_sel_hi:[1,0]
  v_pk_fma_f16 v156, v73, v69, v156 op_sel:[1,1,0] op_sel_hi:[0,1,1] neg_lo:[1,0,0]
  ds_write_addtid_b32 v156 offset:14784
  v_pk_mul_f16 v157, v73, v70 op_sel:[0,0] op_sel_hi:[1,0]
  v_pk_fma_f16 v157, v73, v70, v157 op_sel:[1,1,0] op_sel_hi:[0,1,1] neg_lo:[1,0,0]
  ds_write_addtid_b32 v157 offset:15840
  ds_read_b128 v[32:35], v20 offset:0
  ds_read_b128 v[36:39], v20 offset:64
  ds_read_b128 v[40:43], v20 offset:128
  ds_read_b128 v[44:47], v20 offset:192
  s_waitcnt lgkmcnt(15)
  v_mfma_f32_16x16x32_f16 v[112:115], v[80:83], v[48:51], 0
  v_mfma_f32_16x16x32_f16 v[120:123], v[96:99], v[48:51], 0
  v_mfma_f32_16x16x32_f16 v[112:115], v[84:87], v[52:55], v[112:115]
  v_mfma_f32_16x16x32_f16 v[120:123], v[100:103], v[52:55], v[120:123]
  v_mfma_f32_16x16x32_f16 v[112:115], v[88:91], v[56:59], v[112:115]
  v_mfma_f32_16x16x32_f16 v[120:123], v[104:107], v[56:59], v[120:123]
  v_mfma_f32_16x16x32_f16 v[112:115], v[92:95], v[60:63], v[112:115]
  v_mfma_f32_16x16x32_f16 v[120:123], v[108:111], v[60:63], v[120:123]
  s_waitcnt lgkmcnt(3)
  v_mfma_f32_16x16x32_f16 v[116:119], v[80:83], v[32:35], 0
  v_mfma_f32_16x16x32_f16 v[124:127], v[96:99], v[32:35], 0
  s_waitcnt lgkmcnt(2)
  v_mfma_f32_16x16x32_f16 v[116:119], v[84:87], v[36:39], v[116:119]
  v_mfma_f32_16x16x32_f16 v[124:127], v[100:103], v[36:39], v[124:127]
  s_waitcnt lgkmcnt(1)
  v_mfma_f32_16x16x32_f16 v[116:119], v[88:91], v[40:43], v[116:119]
  v_mfma_f32_16x16x32_f16 v[124:127], v[104:107], v[40:43], v[124:127]
  s_waitcnt lgkmcnt(0)
  v_mfma_f32_16x16x32_f16 v[116:119], v[92:95], v[44:47], v[116:119]
  v_mfma_f32_16x16x32_f16 v[124:127], v[108:111], v[44:47], v[124:127]
  v_mov_b32 v25, s75
  v_mul_f32 v25, s77, v25
  v_add_f32 v25, v25, v25
  v_add_u32 v30, s72, v21
  v_lshlrev_b32 v26, 4, v2
  v_and_b32 v17, 0xffff0000, v17
  s_add_u32 s14, s13, 1008
  v_sub_u32 v27, s14, v26
  s_nop 1
  v_mul_f32 v112, v25, v112
  v_mul_f32 v113, v25, v113
  v_mul_f32 v114, v25, v114
  v_mul_f32 v115, v25, v115
  ds_write_b128 v30, v[112:115] offset:0
  v_mul_f32 v116, v25, v116
  v_mul_f32 v117, v25, v117
  v_mul_f32 v118, v25, v118
  v_mul_f32 v119, v25, v119
  ds_write_b128 v30, v[116:119] offset:4224
  v_mul_f32 v120, v25, v120
  v_mul_f32 v121, v25, v121
  v_mul_f32 v122, v25, v122
  v_mul_f32 v123, v25, v123
  ds_write_b128 v30, v[120:123] offset:8448
  v_mul_f32 v124, v25, v124
  v_mul_f32 v125, v25, v125
  v_mul_f32 v126, v25, v126
  v_mul_f32 v127, v25, v127
  ds_write_b128 v30, v[124:127] offset:12672
Lo_3:
  s_mov_b32 s66, 0x3fb8aa3b
  s_mov_b32 s67, 0x358637bd
  s_waitcnt vmcnt(24) lgkmcnt(0)
  s_barrier
  s_cmp_ge_u32 s4, 16
  s_cbranch_scc1 L_q
  ds_read_b128 v[160:163], v132 offset:21760
  ds_read_b64_tr_b16 v[164:165], v136 offset:21760
  ds_read_b64_tr_b16 v[166:167], v136 offset:22272
  ds_read_b64_tr_b16 v[168:169], v136 offset:29952
  ds_read_b64_tr_b16 v[170:171], v136 offset:30464
  ds_read_b128 v[172:175], v133 offset:21760
  ds_read_b64_tr_b16 v[176:177], v136 offset:23808
  ds_read_b64_tr_b16 v[178:179], v136 offset:24320
  ds_read_b64_tr_b16 v[180:181], v136 offset:32000
  ds_read_b64_tr_b16 v[182:183], v136 offset:32512
  ds_read_b128 v[184:187], v134 offset:21760
  ds_read_b64_tr_b16 v[188:189], v136 offset:25856
  ds_read_b64_tr_b16 v[190:191], v136 offset:26368
  ds_read_b64_tr_b16 v[192:193], v136 offset:34048
  ds_read_b64_tr_b16 v[194:195], v136 offset:34560
  s_waitcnt lgkmcnt(10)
  v_mfma_f32_32x32x16_bf16 v[208:223], v[160:163], v[164:167], 0
  v_mfma_f32_32x32x16_bf16 v[224:239], v[160:163], v[168:171], 0
  ds_read_b128 v[196:199], v135 offset:21760
  ds_read_b64_tr_b16 v[200:201], v136 offset:27904
  ds_read_b64_tr_b16 v[202:203], v136 offset:28416
  ds_read_b64_tr_b16 v[204:205], v136 offset:36096
  ds_read_b64_tr_b16 v[206:207], v136 offset:36608
  s_waitcnt lgkmcnt(10)
  v_mfma_f32_32x32x16_bf16 v[208:223], v[172:175], v[176:179], v[208:223]
  v_mfma_f32_32x32x16_bf16 v[224:239], v[172:175], v[180:183], v[224:239]
  s_cmp_ge_u32 s5, 4
  s_cbranch_scc1 Lo_5
  s_and_b32 s14, s5, 3
  s_mul_i32 s15, s14, 4224
  s_andn2_b32 s74, s72, 0x300
  s_add_u32 s15, s15, s74
  v_add_u32 v30, s15, v21
  ds_read_b128 v[32:35], v30 offset:0
  ds_read_b128 v[36:39], v30 offset:256
  ds_read_b128 v[40:43], v30 offset:512
  ds_read_b128 v[44:47], v30 offset:768
  s_bitcmp0_b32 s5, 1
  s_cbranch_scc1 Lmt_6
  v_mov_b32 v3, v7
  v_mov_b32 v4, v14
  v_mov_b32 v5, v15
  v_mov_b32 v6, v18
Lmt_6:
  s_and_b32 s15, s5, 1
  s_lshl_b32 s15, s15, 8
  v_add_u32 v3, s15, v3
  v_add_u32 v4, s15, v4
  v_add_u32 v5, s15, v5
  v_add_u32 v6, s15, v6
  s_cmp_eq_u32 s14, 0
  s_cselect_b32 s74, 1, 0
  s_mov_b32 s75, 0
  s_waitcnt lgkmcnt(0)
  v_add_f32 v32, v32, v36
  v_add_f32 v40, v40, v44
  v_add_f32 v33, v33, v37
  v_add_f32 v41, v41, v45
  v_add_f32 v34, v34, v38
  v_add_f32 v42, v42, v46
  v_add_f32 v35, v35, v39
  v_add_f32 v43, v43, v47
  v_add_f32 v32, v32, v40
  v_add_f32 v33, v33, v41
  v_add_f32 v34, v34, v42
  v_add_f32 v35, v35, v43
  s_mov_b64 exec, s[74:75]
  v_add_f32 v32, v32, v17
  s_mov_b64 exec, -1
  v_cvt_pk_bf16_f32 v36, v32, v33
  v_cvt_pk_bf16_f32 v37, v34, v35
  ds_write_b16 v3, v36
  ds_write_b16_d16_hi v4, v36
  ds_write_b16 v5, v37
  ds_write_b16_d16_hi v6, v37
  s_waitcnt lgkmcnt(0)
Lo_5:
  s_waitcnt vmcnt(16)
  s_barrier
  s_waitcnt lgkmcnt(5)
  v_mfma_f32_32x32x16_bf16 v[208:223], v[184:187], v[188:191], v[208:223]
  v_mfma_f32_32x32x16_bf16 v[224:239], v[184:187], v[192:195], v[224:239]
  ds_read_b128 v[160:163], v132 offset:54528
  ds_read_b64_tr_b16 v[164:165], v136 offset:54528
  ds_read_b64_tr_b16 v[166:167], v136 offset:55040
  ds_read_b64_tr_b16 v[168:169], v136 offset:62720
  ds_read_b64_tr_b16 v[170:171], v136 offset:63232
  s_waitcnt lgkmcnt(5)
  v_mfma_f32_32x32x16_bf16 v[208:223], v[196:199], v[200:203], v[208:223]
  v_mfma_f32_32x32x16_bf16 v[224:239], v[196:199], v[204:207], v[224:239]
  ds_read_b128 v[172:175], v133 offset:54528
  ds_read_b64_tr_b16 v[176:177], v136 offset:56576
  ds_read_b64_tr_b16 v[178:179], v136 offset:57088
  ds_read_b64_tr_b16 v[180:181], v136 offset:64768
  ds_read_b64_tr_b16 v[182:183], v136 offset:65280
  ds_read_b128 v[184:187], v134 offset:54528
  ds_read_b64_tr_b16 v[188:189], v136 offset:58624
  ds_read_b64_tr_b16 v[190:191], v136 offset:59136
  ds_read_b64_tr_b16 v[192:193], v144 offset:1280
  ds_read_b64_tr_b16 v[194:195], v144 offset:1792
  s_waitcnt lgkmcnt(10)
  v_mfma_f32_32x32x16_bf16 v[208:223], v[160:163], v[164:167], v[208:223]
  v_mfma_f32_32x32x16_bf16 v[224:239], v[160:163], v[168:171], v[224:239]
  ds_read_b128 v[196:199], v135 offset:54528
  ds_read_b64_tr_b16 v[200:201], v136 offset:60672
  ds_read_b64_tr_b16 v[202:203], v136 offset:61184
  ds_read_b64_tr_b16 v[204:205], v144 offset:3328
  ds_read_b64_tr_b16 v[206:207], v144 offset:3840
  s_waitcnt lgkmcnt(10)
  v_mfma_f32_32x32x16_bf16 v[208:223], v[172:175], v[176:179], v[208:223]
  v_mfma_f32_32x32x16_bf16 v[224:239], v[172:175], v[180:183], v[224:239]
  s_cmp_ge_u32 s5, 4
  s_cbranch_scc1 Lo_7
  s_and_b32 s14, s5, 3
  s_mul_i32 s15, s7, 4224
  s_lshl_b32 s74, s14, 10
  s_add_u32 s77, s15, 4096
  s_add_u32 s15, s15, s74
  s_mov_b32 s74, 0x05040504
  s_mov_b32 s75, 0x01000100
  s_mov_b32 s76, 0x01000504
  v_mov_b32 v84, 0
  v_mov_b32 v85, 0
  v_mov_b32 v86, 0
  v_mov_b32 v87, 0
  s_cmp_eq_u32 s14, 3
  s_cbranch_scc1 Lm3_9
  s_cmp_eq_u32 s14, 2
  s_cbranch_scc1 Lm2_8
  s_lshl_b32 s14, s14, 10
  v_subrev_u32 v28, s14, v27
  ds_read_u16 v80, v28 offset:3072
  ds_read_u16 v81, v28 offset:3088
  v_and_b32 v31, 1, v2
  v_mul_u32_u24 v31, 0x0404, v31
  v_lshlrev_b32 v31, 16, v31
  v_sub_u32 v31, 0x05040504, v31
  s_waitcnt lgkmcnt(0)
  v_perm_b32 v48, v81, v80, s74
  v_perm_b32 v49, v81, v80, v31
  v_perm_b32 v50, v81, v80, s75
  v_perm_b32 v51, v81, v80, s75
  s_branch Lme_10
Lm2_8:
  ds_read_u16 v88, v27 offset:1024
  ds_read_u16 v89, v27 offset:1032
  ds_read_u16 v90, v27 offset:1040
  s_waitcnt lgkmcnt(0)
  v_perm_b32 v48, v90, v90, s75
  v_perm_b32 v49, v89, v88, s74
  v_perm_b32 v50, v89, v88, s76
  v_perm_b32 v51, v89, v88, s75
  s_branch Lme_10
Lm3_9:
  v_cmp_gt_u32 vcc, 32, v2
  s_nop 1
  v_cndmask_b32_e64 v28, 0, 2, vcc
  v_add_u32 v29, v27, v28
  v_sub_u32 v30, v27, v28
  ds_read_u16 v92, v29 offset:14
  ds_read_u16 v93, v27 offset:12
  ds_read_u16 v94, v30 offset:10
  ds_read_u16 v95, v27 offset:8
  ds_read_u16 v96, v29 offset:6
  ds_read_u16 v97, v27 offset:4
  ds_read_u16 v98, v30 offset:2
  ds_read_u16 v99, v27 offset:0
  s_waitcnt lgkmcnt(0)
  v_lshl_or_b32 v48, v93, 16, v92
  v_lshl_or_b32 v49, v95, 16, v94
  v_lshl_or_b32 v50, v97, 16, v96
  v_lshl_or_b32 v51, v99, 16, v98
Lme_10:
  buffer_store_dwordx4 v[48:51], v26, s[52:55], s15 offen sc1
  s_mov_b64 exec, 1
  buffer_store_dwordx4 v[84:87], v26, s[52:55], s77 offen sc1
  s_mov_b64 exec, -1
Lo_7:
  s_waitcnt vmcnt(8)
  s_barrier
  s_waitcnt lgkmcnt(5)
  v_mfma_f32_32x32x16_bf16 v[208:223], v[184:187], v[188:191], v[208:223]
  v_mfma_f32_32x32x16_bf16 v[224:239], v[184:187], v[192:195], v[224:239]
  s_lshl_b32 s6, s73, 7
  s_mul_i32 s12, s73, 172032
  s_add_u32 s73, s73, 1
  s_cmp_eq_u32 s73, 7
  s_cselect_b32 s73, 0, s73
  s_add_u32 s6, s6, s42
  s_add_u32 m0, s10, 21760
  s_add_u32 s12, s12, s43
  buffer_load_dwordx4 v128, s[44:47], s6 offen lds
  ds_read_b128 v[160:163], v140 offset:21760
  ds_read_b64_tr_b16 v[164:165], v144 offset:21760
  ds_read_b64_tr_b16 v[166:167], v144 offset:22272
  ds_read_b64_tr_b16 v[168:169], v144 offset:29952
  ds_read_b64_tr_b16 v[170:171], v144 offset:30464
  s_waitcnt lgkmcnt(5)
  v_mfma_f32_32x32x16_bf16 v[208:223], v[196:199], v[200:203], v[208:223]
  v_mfma_f32_32x32x16_bf16 v[224:239], v[196:199], v[204:207], v[224:239]
  s_add_u32 m0, s11, 21760
  s_nop 0
  buffer_load_dwordx4 v130, s[48:51], s12 offen lds
  ds_read_b128 v[172:175], v141 offset:21760
  ds_read_b64_tr_b16 v[176:177], v144 offset:23808
  ds_read_b64_tr_b16 v[178:179], v144 offset:24320
  ds_read_b64_tr_b16 v[180:181], v144 offset:32000
  ds_read_b64_tr_b16 v[182:183], v144 offset:32512
  ds_read_b128 v[184:187], v142 offset:21760
  ds_read_b64_tr_b16 v[188:189], v144 offset:25856
  ds_read_b64_tr_b16 v[190:191], v144 offset:26368
  ds_read_b64_tr_b16 v[192:193], v144 offset:34048
  ds_read_b64_tr_b16 v[194:195], v144 offset:34560
  s_waitcnt lgkmcnt(10)
  v_mfma_f32_32x32x16_bf16 v[208:223], v[160:163], v[164:167], v[208:223]
  v_mfma_f32_32x32x16_bf16 v[224:239], v[160:163], v[168:171], v[224:239]
  s_add_u32 m0, s10, 22784
  s_nop 0
  buffer_load_dwordx4 v129, s[44:47], s6 offen lds
  ds_read_b128 v[196:199], v143 offset:21760
  ds_read_b64_tr_b16 v[200:201], v144 offset:27904
  ds_read_b64_tr_b16 v[202:203], v144 offset:28416
  ds_read_b64_tr_b16 v[204:205], v144 offset:36096
  ds_read_b64_tr_b16 v[206:207], v144 offset:36608
  s_waitcnt lgkmcnt(10)
  v_mfma_f32_32x32x16_bf16 v[208:223], v[172:175], v[176:179], v[208:223]
  v_mfma_f32_32x32x16_bf16 v[224:239], v[172:175], v[180:183], v[224:239]
  s_add_u32 m0, s11, 29952
  s_nop 0
  buffer_load_dwordx4 v131, s[48:51], s12 offen lds
  s_waitcnt vmcnt(4)
  s_barrier
  s_waitcnt lgkmcnt(5)
  v_mfma_f32_32x32x16_bf16 v[208:223], v[184:187], v[188:191], v[208:223]
  v_mfma_f32_32x32x16_bf16 v[224:239], v[184:187], v[192:195], v[224:239]
  s_lshl_b32 s6, s73, 7
  s_mul_i32 s12, s73, 172032
  s_add_u32 s73, s73, 1
  s_cmp_eq_u32 s73, 7
  s_cselect_b32 s73, 0, s73
  s_add_u32 s6, s6, s42
  s_add_u32 m0, s10, 54528
  s_add_u32 s12, s12, s43
  buffer_load_dwordx4 v128, s[44:47], s6 offen lds
  ds_read_b128 v[160:163], v140 offset:54528
  ds_read_b64_tr_b16 v[164:165], v144 offset:54528
  ds_read_b64_tr_b16 v[166:167], v144 offset:55040
  ds_read_b64_tr_b16 v[168:169], v144 offset:62720
  ds_read_b64_tr_b16 v[170:171], v144 offset:63232
  s_waitcnt lgkmcnt(5)
  v_mfma_f32_32x32x16_bf16 v[208:223], v[196:199], v[200:203], v[208:223]
  v_mfma_f32_32x32x16_bf16 v[224:239], v[196:199], v[204:207], v[224:239]
  s_add_u32 m0, s11, 54528
  s_nop 0
  buffer_load_dwordx4 v130, s[48:51], s12 offen lds
  ds_read_b128 v[172:175], v141 offset:54528
  ds_read_b64_tr_b16 v[176:177], v144 offset:56576
  ds_read_b64_tr_b16 v[178:179], v144 offset:57088
  ds_read_b64_tr_b16 v[180:181], v144 offset:64768
  ds_read_b64_tr_b16 v[182:183], v144 offset:65280
  ds_read_b128 v[184:187], v142 offset:54528
  ds_read_b64_tr_b16 v[188:189], v144 offset:58624
  ds_read_b64_tr_b16 v[190:191], v144 offset:59136
  ds_read_b64_tr_b16 v[192:193], v152 offset:1280
  ds_read_b64_tr_b16 v[194:195], v152 offset:1792
  s_waitcnt lgkmcnt(10)
  v_mfma_f32_32x32x16_bf16 v[208:223], v[160:163], v[164:167], v[208:223]
  v_mfma_f32_32x32x16_bf16 v[224:239], v[160:163], v[168:171], v[224:239]
  s_add_u32 m0, s10, 55552
  s_nop 0
  buffer_load_dwordx4 v129, s[44:47], s6 offen lds
  ds_read_b128 v[196:199], v143 offset:54528
  ds_read_b64_tr_b16 v[200:201], v144 offset:60672
  ds_read_b64_tr_b16 v[202:203], v144 offset:61184
  ds_read_b64_tr_b16 v[204:205], v152 offset:3328
  ds_read_b64_tr_b16 v[206:207], v152 offset:3840
  s_waitcnt lgkmcnt(10)
  v_mfma_f32_32x32x16_bf16 v[208:223], v[172:175], v[176:179], v[208:223]
  v_mfma_f32_32x32x16_bf16 v[224:239], v[172:175], v[180:183], v[224:239]
  s_add_u32 m0, s11, 62720
  s_nop 0
  buffer_load_dwordx4 v131, s[48:51], s12 offen lds
  s_waitcnt vmcnt(4)
  s_barrier
  s_cmp_ge_u32 s5, 4
  s_cbranch_scc1 Lo_11
  buffer_load_dword v145, v146, s[60:63], 0 offen sc1
Lo_11:
  s_waitcnt lgkmcnt(5)
  v_mfma_f32_32x32x16_bf16 v[208:223], v[184:187], v[188:191], v[208:223]
  v_mfma_f32_32x32x16_bf16 v[224:239], v[184:187], v[192:195], v[224:239]
  s_lshl_b32 s6, s73, 7
  s_mul_i32 s12, s73, 172032
  s_add_u32 s73, s73, 1
  s_cmp_eq_u32 s73, 7
  s_cselect_b32 s73, 0, s73
  s_add_u32 s6, s6, s42
  s_add_u32 m0, s10, 87296
  s_add_u32 s12, s12, s43
  buffer_load_dwordx4 v128, s[44:47], s6 offen lds
  ds_read_b128 v[160:163], v132 offset:21760
  ds_read_b64_tr_b16 v[164:165], v136 offset:21760
  ds_read_b64_tr_b16 v[166:167], v136 offset:22272
  ds_read_b64_tr_b16 v[168:169], v136 offset:29952
  ds_read_b64_tr_b16 v[170:171], v136 offset:30464
  s_waitcnt lgkmcnt(5)
  v_mfma_f32_32x32x16_bf16 v[208:223], v[196:199], v[200:203], v[208:223]
  v_mfma_f32_32x32x16_bf16 v[224:239], v[196:199], v[204:207], v[224:239]
  s_add_u32 m0, s11, 87296
  s_nop 0
  buffer_load_dwordx4 v130, s[48:51], s12 offen lds
  ds_read_b128 v[172:175], v133 offset:21760
  ds_read_b64_tr_b16 v[176:177], v136 offset:23808
  ds_read_b64_tr_b16 v[178:179], v136 offset:24320
  ds_read_b64_tr_b16 v[180:181], v136 offset:32000
  ds_read_b64_tr_b16 v[182:183], v136 offset:32512
  ds_read_b128 v[184:187], v134 offset:21760
  ds_read_b64_tr_b16 v[188:189], v136 offset:25856
  ds_read_b64_tr_b16 v[190:191], v136 offset:26368
  ds_read_b64_tr_b16 v[192:193], v136 offset:34048
  ds_read_b64_tr_b16 v[194:195], v136 offset:34560
  s_waitcnt lgkmcnt(10)
  v_mfma_f32_32x32x16_bf16 v[208:223], v[160:163], v[164:167], v[208:223]
  v_mfma_f32_32x32x16_bf16 v[224:239], v[160:163], v[168:171], v[224:239]
  s_add_u32 m0, s10, 88320
  s_nop 0
  buffer_load_dwordx4 v129, s[44:47], s6 offen lds
  ds_read_b128 v[196:199], v135 offset:21760
  ds_read_b64_tr_b16 v[200:201], v136 offset:27904
  ds_read_b64_tr_b16 v[202:203], v136 offset:28416
  ds_read_b64_tr_b16 v[204:205], v136 offset:36096
  ds_read_b64_tr_b16 v[206:207], v136 offset:36608
  s_waitcnt lgkmcnt(10)
  v_mfma_f32_32x32x16_bf16 v[208:223], v[172:175], v[176:179], v[208:223]
  v_mfma_f32_32x32x16_bf16 v[224:239], v[172:175], v[180:183], v[224:239]
  s_add_u32 m0, s11, 95488
  s_nop 0
  buffer_load_dwordx4 v131, s[48:51], s12 offen lds
  s_waitcnt vmcnt(4)
  s_barrier
  s_waitcnt lgkmcnt(5)
  v_mfma_f32_32x32x16_bf16 v[208:223], v[184:187], v[188:191], v[208:223]
  v_mfma_f32_32x32x16_bf16 v[224:239], v[184:187], v[192:195], v[224:239]
  ds_read_b128 v[160:163], v132 offset:54528
  ds_read_b64_tr_b16 v[164:165], v136 offset:54528
  ds_read_b64_tr_b16 v[166:167], v136 offset:55040
  ds_read_b64_tr_b16 v[168:169], v136 offset:62720
  ds_read_b64_tr_b16 v[170:171], v136 offset:63232
  s_waitcnt lgkmcnt(5)
  v_mfma_f32_32x32x16_bf16 v[208:223], v[196:199], v[200:203], v[208:223]
  v_mfma_f32_32x32x16_bf16 v[224:239], v[196:199], v[204:207], v[224:239]
  ds_read_b128 v[172:175], v133 offset:54528
  ds_read_b64_tr_b16 v[176:177], v136 offset:56576
  ds_read_b64_tr_b16 v[178:179], v136 offset:57088
  ds_read_b64_tr_b16 v[180:181], v136 offset:64768
  ds_read_b64_tr_b16 v[182:183], v136 offset:65280
  ds_read_b128 v[184:187], v134 offset:54528
  ds_read_b64_tr_b16 v[188:189], v136 offset:58624
  ds_read_b64_tr_b16 v[190:191], v136 offset:59136
  ds_read_b64_tr_b16 v[192:193], v144 offset:1280
  ds_read_b64_tr_b16 v[194:195], v144 offset:1792
  s_waitcnt lgkmcnt(10)
  v_mfma_f32_32x32x16_bf16 v[208:223], v[160:163], v[164:167], v[208:223]
  v_mfma_f32_32x32x16_bf16 v[224:239], v[160:163], v[168:171], v[224:239]
  ds_read_b128 v[196:199], v135 offset:54528
  ds_read_b64_tr_b16 v[200:201], v136 offset:60672
  ds_read_b64_tr_b16 v[202:203], v136 offset:61184
  ds_read_b64_tr_b16 v[204:205], v144 offset:3328
  ds_read_b64_tr_b16 v[206:207], v144 offset:3840
  s_waitcnt lgkmcnt(10)
  v_mfma_f32_32x32x16_bf16 v[208:223], v[172:175], v[176:179], v[208:223]
  v_mfma_f32_32x32x16_bf16 v[224:239], v[172:175], v[180:183], v[224:239]
  s_waitcnt vmcnt(0)
  s_barrier
  s_waitcnt lgkmcnt(5)
  v_mfma_f32_32x32x16_bf16 v[208:223], v[184:187], v[188:191], v[208:223]
  v_mfma_f32_32x32x16_bf16 v[224:239], v[184:187], v[192:195], v[224:239]
  ds_read_b128 v[160:163], v140 offset:21760
  ds_read_b64_tr_b16 v[164:165], v144 offset:21760
  ds_read_b64_tr_b16 v[166:167], v144 offset:22272
  ds_read_b64_tr_b16 v[168:169], v144 offset:29952
  ds_read_b64_tr_b16 v[170:171], v144 offset:30464
  s_waitcnt lgkmcnt(5)
  v_mfma_f32_32x32x16_bf16 v[208:223], v[196:199], v[200:203], v[208:223]
  v_mfma_f32_32x32x16_bf16 v[224:239], v[196:199], v[204:207], v[224:239]
  ds_read_b128 v[172:175], v141 offset:21760
  ds_read_b64_tr_b16 v[176:177], v144 offset:23808
  ds_read_b64_tr_b16 v[178:179], v144 offset:24320
  ds_read_b64_tr_b16 v[180:181], v144 offset:32000
  ds_read_b64_tr_b16 v[182:183], v144 offset:32512
  s_cmp_lg_u32 s5, 0
  s_cbranch_scc1 Lkf_12
  s_movk_i32 s64, 3000
Lwi_13:
  s_waitcnt vmcnt(0)
  v_cmp_ne_u32 vcc, 1, v145
  s_sub_u32 s64, s64, 1
  s_cbranch_scc1 Lwik_14
  s_cbranch_vccz Lwik_14
  s_sleep 2
  buffer_load_dword v145, v146, s[60:63], 0 offen sc1
  s_branch Lwi_13
Lwik_14:
  s_lshl_b32 s14, s7, 5
  s_add_u32 s14, s14, 16384
  v_mov_b32 v139, 1
  s_mov_b64 exec, 1
  buffer_store_dword v139, v138, s[56:59], s14 offen sc1
  s_mov_b64 exec, -1
Lkf_12:
  ds_read_b128 v[184:187], v142 offset:21760
  ds_read_b64_tr_b16 v[188:189], v144 offset:25856
  ds_read_b64_tr_b16 v[190:191], v144 offset:26368
  ds_read_b64_tr_b16 v[192:193], v144 offset:34048
  ds_read_b64_tr_b16 v[194:195], v144 offset:34560
  s_waitcnt lgkmcnt(10)
  v_mfma_f32_32x32x16_bf16 v[208:223], v[160:163], v[164:167], v[208:223]
  v_mfma_f32_32x32x16_bf16 v[224:239], v[160:163], v[168:171], v[224:239]
  ds_read_b128 v[196:199], v143 offset:21760
  ds_read_b64_tr_b16 v[200:201], v144 offset:27904
  ds_read_b64_tr_b16 v[202:203], v144 offset:28416
  ds_read_b64_tr_b16 v[204:205], v144 offset:36096
  ds_read_b64_tr_b16 v[206:207], v144 offset:36608
  s_waitcnt lgkmcnt(10)
  v_mfma_f32_32x32x16_bf16 v[208:223], v[172:175], v[176:179], v[208:223]
  v_mfma_f32_32x32x16_bf16 v[224:239], v[172:175], v[180:183], v[224:239]
  s_waitcnt lgkmcnt(5)
  v_mfma_f32_32x32x16_bf16 v[208:223], v[184:187], v[188:191], v[208:223]
  v_mfma_f32_32x32x16_bf16 v[224:239], v[184:187], v[192:195], v[224:239]
  s_waitcnt lgkmcnt(0)
  v_mfma_f32_32x32x16_bf16 v[208:223], v[196:199], v[200:203], v[208:223]
  v_mfma_f32_32x32x16_bf16 v[224:239], v[196:199], v[204:207], v[224:239]
  s_mov_b32 s52, s40
  s_mov_b32 s53, s41
  s_mov_b32 s54, 0x10000
  s_mov_b32 s55, 0x20000
  v_lshlrev_b32 v10, 4, v2
  s_lshl_b32 s14, s5, 12
  s_add_u32 s14, s14, 21760
  v_add_u32 v11, s14, v10
  s_and_b32 s14, s5, 3
  s_lshl_b32 s14, s14, 10
  s_lshl_b32 s15, s65, 14
  s_add_u32 s14, s14, s15
  s_add_u32 s14, s14, 21760
  v_add_u32 v12, s14, v138
  s_nop 1
  v_cvt_pk_bf16_f32 v48, v208, v209
  v_cvt_pk_bf16_f32 v52, v210, v211
  v_and_b32 v49, 0xffff0000, v48
  v_lshlrev_b32 v48, 16, v48
  v_and_b32 v53, 0xffff0000, v52
  v_lshlrev_b32 v52, 16, v52
  v_mul_f32 v50, s66, v48
  v_mul_f32 v51, s66, v49
  v_mul_f32 v54, s66, v52
  v_mul_f32 v55, s66, v53
  v_exp_f32_e64 v50, v50 clamp
  v_exp_f32_e64 v51, v51 clamp
  v_exp_f32_e64 v54, v54 clamp
  v_exp_f32_e64 v55, v55 clamp
  v_max_f32 v48, s67, v48
  v_max_f32 v49, s67, v49
  v_max_f32 v52, s67, v52
  v_max_f32 v53, s67, v53
  v_add_f32 v48, v48, v50
  v_add_f32 v49, v49, v51
  v_add_f32 v52, v52, v54
  v_add_f32 v53, v53, v55
  v_cvt_pk_bf16_f32 v32, v48, v49
  v_cvt_pk_bf16_f32 v33, v52, v53
  v_cvt_pk_bf16_f32 v48, v212, v213
  v_cvt_pk_bf16_f32 v52, v214, v215
  v_and_b32 v49, 0xffff0000, v48
  v_lshlrev_b32 v48, 16, v48
  v_and_b32 v53, 0xffff0000, v52
  v_lshlrev_b32 v52, 16, v52
  v_mul_f32 v50, s66, v48
  v_mul_f32 v51, s66, v49
  v_mul_f32 v54, s66, v52
  v_mul_f32 v55, s66, v53
  v_exp_f32_e64 v50, v50 clamp
  v_exp_f32_e64 v51, v51 clamp
  v_exp_f32_e64 v54, v54 clamp
  v_exp_f32_e64 v55, v55 clamp
  v_max_f32 v48, s67, v48
  v_max_f32 v49, s67, v49
  v_max_f32 v52, s67, v52
  v_max_f32 v53, s67, v53
  v_add_f32 v48, v48, v50
  v_add_f32 v49, v49, v51
  v_add_f32 v52, v52, v54
  v_add_f32 v53, v53, v55
  v_cvt_pk_bf16_f32 v34, v48, v49
  v_cvt_pk_bf16_f32 v35, v52, v53
  v_cvt_pk_bf16_f32 v48, v216, v217
  v_cvt_pk_bf16_f32 v52, v218, v219
  v_and_b32 v49, 0xffff0000, v48
  v_lshlrev_b32 v48, 16, v48
  v_and_b32 v53, 0xffff0000, v52
  v_lshlrev_b32 v52, 16, v52
  v_mul_f32 v50, s66, v48
  v_mul_f32 v51, s66, v49
  v_mul_f32 v54, s66, v52
  v_mul_f32 v55, s66, v53
  v_exp_f32_e64 v50, v50 clamp
  v_exp_f32_e64 v51, v51 clamp
  v_exp_f32_e64 v54, v54 clamp
  v_exp_f32_e64 v55, v55 clamp
  v_max_f32 v48, s67, v48
  v_max_f32 v49, s67, v49
  v_max_f32 v52, s67, v52
  v_max_f32 v53, s67, v53
  v_add_f32 v48, v48, v50
  v_add_f32 v49, v49, v51
  v_add_f32 v52, v52, v54
  v_add_f32 v53, v53, v55
  v_cvt_pk_bf16_f32 v36, v48, v49
  v_cvt_pk_bf16_f32 v37, v52, v53
  v_cvt_pk_bf16_f32 v48, v220, v221
  v_cvt_pk_bf16_f32 v52, v222, v223
  v_and_b32 v49, 0xffff0000, v48
  v_lshlrev_b32 v48, 16, v48
  v_and_b32 v53, 0xffff0000, v52
  v_lshlrev_b32 v52, 16, v52
  v_mul_f32 v50, s66, v48
  v_mul_f32 v51, s66, v49
  v_mul_f32 v54, s66, v52
  v_mul_f32 v55, s66, v53
  v_exp_f32_e64 v50, v50 clamp
  v_exp_f32_e64 v51, v51 clamp
  v_exp_f32_e64 v54, v54 clamp
  v_exp_f32_e64 v55, v55 clamp
  v_max_f32 v48, s67, v48
  v_max_f32 v49, s67, v49
  v_max_f32 v52, s67, v52
  v_max_f32 v53, s67, v53
  v_add_f32 v48, v48, v50
  v_add_f32 v49, v49, v51
  v_add_f32 v52, v52, v54
  v_add_f32 v53, v53, v55
  v_cvt_pk_bf16_f32 v38, v48, v49
  v_cvt_pk_bf16_f32 v39, v52, v53
  v_cvt_pk_bf16_f32 v40, v224, v225
  v_cvt_pk_bf16_f32 v41, v226, v227
  v_cvt_pk_bf16_f32 v42, v228, v229
  v_cvt_pk_bf16_f32 v43, v230, v231
  v_cvt_pk_bf16_f32 v44, v232, v233
  v_cvt_pk_bf16_f32 v45, v234, v235
  v_cvt_pk_bf16_f32 v46, v236, v237
  v_cvt_pk_bf16_f32 v47, v238, v239
  s_mov_b32 exec_lo, 0x10000000
  s_mov_b32 exec_hi, 0x10000000
  v_mov_b32 v40, 0x3f803f80
  v_mov_b32 v41, 0x3f803f80
  v_mov_b32 v42, 0x3f803f80
  v_mov_b32 v43, 0x3f803f80
  v_mov_b32 v44, 0x3f803f80
  v_mov_b32 v45, 0x3f803f80
  v_mov_b32 v46, 0x3f803f80
  v_mov_b32 v47, 0x3f803f80
  s_mov_b64 exec, -1
  s_nop 1
  v_mfma_f32_32x32x16_bf16 v[56:71], v[32:35], v[40:43], 0
  v_mfma_f32_32x32x16_bf16 v[56:71], v[36:39], v[44:47], v[56:71]
  s_lshl_b32 s14, s9, 1
  s_add_u32 s14, s14, s65
  s_lshl_b32 s14, s14, 12
  s_and_b32 s15, s5, 3
  s_lshl_b32 s15, s15, 10
  s_add_u32 s14, s14, s15
  s_nop 6
  ds_write_b128 v11, v[56:59] offset:0
  ds_write_b128 v11, v[60:63] offset:1024
  ds_write_b128 v11, v[64:67] offset:2048
  ds_write_b128 v11, v[68:71] offset:3072
  s_waitcnt lgkmcnt(0)
  s_barrier
  ds_read2st64_b32 v[32:33], v12 offset0:0 offset1:16
  ds_read2st64_b32 v[34:35], v12 offset0:32 offset1:48
  ds_read2st64_b32 v[36:37], v12 offset0:1 offset1:17
  ds_read2st64_b32 v[38:39], v12 offset0:33 offset1:49
  ds_read2st64_b32 v[40:41], v12 offset0:2 offset1:18
  ds_read2st64_b32 v[42:43], v12 offset0:34 offset1:50
  ds_read2st64_b32 v[44:45], v12 offset0:3 offset1:19
  ds_read2st64_b32 v[46:47], v12 offset0:35 offset1:51
  s_waitcnt lgkmcnt(6)
  v_add_f32 v32, v32, v33
  v_add_f32 v34, v34, v35
  v_add_f32 v32, v32, v34
  buffer_atomic_add_f32 v32, v138, s[52:55], s14 offen offset:0
  s_waitcnt lgkmcnt(4)
  v_add_f32 v36, v36, v37
  v_add_f32 v38, v38, v39
  v_add_f32 v36, v36, v38
  buffer_atomic_add_f32 v36, v138, s[52:55], s14 offen offset:256
  s_waitcnt lgkmcnt(2)
  v_add_f32 v40, v40, v41
  v_add_f32 v42, v42, v43
  v_add_f32 v40, v40, v42
  buffer_atomic_add_f32 v40, v138, s[52:55], s14 offen offset:512
  s_waitcnt lgkmcnt(0)
  v_add_f32 v44, v44, v45
  v_add_f32 v46, v46, v47
  v_add_f32 v44, v44, v46
  buffer_atomic_add_f32 v44, v138, s[52:55], s14 offen offset:768
  s_waitcnt vmcnt(0)
  s_barrier
  s_cmp_lg_u32 s5, 0
  s_cbranch_scc1 Lvf_15
  s_lshl_b32 s14, s3, 4
  s_add_u32 s14, s14, s4
  s_lshl_b32 s14, s14, 5
  s_add_u32 s14, s14, 4096
  v_mov_b32 v139, 1
  s_mov_b64 exec, 1
  buffer_store_dword v139, v138, s[56:59], s14 offen sc1
  s_mov_b64 exec, -1
Lvf_15:
  s_cmp_lt_u32 s4, 14
  s_cbranch_scc1 L_w4
  s_endpgm
L_q:
  ds_read_b128 v[160:163], v132 offset:21760
  ds_read_b64_tr_b16 v[164:165], v136 offset:21760
  ds_read_b64_tr_b16 v[166:167], v136 offset:22272
  ds_read_b64_tr_b16 v[168:169], v136 offset:29952
  ds_read_b64_tr_b16 v[170:171], v136 offset:30464
  ds_read_b128 v[172:175], v133 offset:21760
  ds_read_b64_tr_b16 v[176:177], v136 offset:23808
  ds_read_b64_tr_b16 v[178:179], v136 offset:24320
  ds_read_b64_tr_b16 v[180:181], v136 offset:32000
  ds_read_b64_tr_b16 v[182:183], v136 offset:32512
  ds_read_b128 v[184:187], v134 offset:21760
  ds_read_b64_tr_b16 v[188:189], v136 offset:25856
  ds_read_b64_tr_b16 v[190:191], v136 offset:26368
  ds_read_b64_tr_b16 v[192:193], v136 offset:34048
  ds_read_b64_tr_b16 v[194:195], v136 offset:34560
  s_waitcnt lgkmcnt(10)
  v_mfma_f32_32x32x16_bf16 v[208:223], v[164:167], v[160:163], 0
  v_mfma_f32_32x32x16_bf16 v[224:239], v[168:171], v[160:163], 0
  ds_read_b128 v[196:199], v135 offset:21760
  ds_read_b64_tr_b16 v[200:201], v136 offset:27904
  ds_read_b64_tr_b16 v[202:203], v136 offset:28416
  ds_read_b64_tr_b16 v[204:205], v136 offset:36096
  ds_read_b64_tr_b16 v[206:207], v136 offset:36608
  s_waitcnt lgkmcnt(10)
  v_mfma_f32_32x32x16_bf16 v[208:223], v[176:179], v[172:175], v[208:223]
  v_mfma_f32_32x32x16_bf16 v[224:239], v[180:183], v[172:175], v[224:239]
  s_cmp_ge_u32 s5, 4
  s_cbranch_scc1 Lo_16
  s_and_b32 s14, s5, 3
  s_mul_i32 s15, s14, 4224
  s_andn2_b32 s74, s72, 0x300
  s_add_u32 s15, s15, s74
  v_add_u32 v30, s15, v21
  ds_read_b128 v[32:35], v30 offset:0
  ds_read_b128 v[36:39], v30 offset:256
  ds_read_b128 v[40:43], v30 offset:512
  ds_read_b128 v[44:47], v30 offset:768
  s_bitcmp0_b32 s5, 1
  s_cbranch_scc1 Lmt_17
  v_mov_b32 v3, v7
  v_mov_b32 v4, v14
  v_mov_b32 v5, v15
  v_mov_b32 v6, v18
Lmt_17:
  s_and_b32 s15, s5, 1
  s_lshl_b32 s15, s15, 8
  v_add_u32 v3, s15, v3
  v_add_u32 v4, s15, v4
  v_add_u32 v5, s15, v5
  v_add_u32 v6, s15, v6
  s_cmp_eq_u32 s14, 0
  s_cselect_b32 s74, 1, 0
  s_mov_b32 s75, 0
  s_waitcnt lgkmcnt(0)
  v_add_f32 v32, v32, v36
  v_add_f32 v40, v40, v44
  v_add_f32 v33, v33, v37
  v_add_f32 v41, v41, v45
  v_add_f32 v34, v34, v38
  v_add_f32 v42, v42, v46
  v_add_f32 v35, v35, v39
  v_add_f32 v43, v43, v47
  v_add_f32 v32, v32, v40
  v_add_f32 v33, v33, v41
  v_add_f32 v34, v34, v42
  v_add_f32 v35, v35, v43
  s_mov_b64 exec, s[74:75]
  v_add_f32 v32, v32, v17
  s_mov_b64 exec, -1
  v_cvt_pk_bf16_f32 v36, v32, v33
  v_cvt_pk_bf16_f32 v37, v34, v35
  ds_write_b16 v3, v36
  ds_write_b16_d16_hi v4, v36
  ds_write_b16 v5, v37
  ds_write_b16_d16_hi v6, v37
  s_waitcnt lgkmcnt(0)
Lo_16:
  s_waitcnt vmcnt(16)
  s_barrier
  s_waitcnt lgkmcnt(5)
  v_mfma_f32_32x32x16_bf16 v[208:223], v[188:191], v[184:187], v[208:223]
  v_mfma_f32_32x32x16_bf16 v[224:239], v[192:195], v[184:187], v[224:239]
  ds_read_b128 v[160:163], v132 offset:54528
  ds_read_b64_tr_b16 v[164:165], v136 offset:54528
  ds_read_b64_tr_b16 v[166:167], v136 offset:55040
  ds_read_b64_tr_b16 v[168:169], v136 offset:62720
  ds_read_b64_tr_b16 v[170:171], v136 offset:63232
  s_waitcnt lgkmcnt(5)
  v_mfma_f32_32x32x16_bf16 v[208:223], v[200:203], v[196:199], v[208:223]
  v_mfma_f32_32x32x16_bf16 v[224:239], v[204:207], v[196:199], v[224:239]
  ds_read_b128 v[172:175], v133 offset:54528
  ds_read_b64_tr_b16 v[176:177], v136 offset:56576
  ds_read_b64_tr_b16 v[178:179], v136 offset:57088
  ds_read_b64_tr_b16 v[180:181], v136 offset:64768
  ds_read_b64_tr_b16 v[182:183], v136 offset:65280
  ds_read_b128 v[184:187], v134 offset:54528
  ds_read_b64_tr_b16 v[188:189], v136 offset:58624
  ds_read_b64_tr_b16 v[190:191], v136 offset:59136
  ds_read_b64_tr_b16 v[192:193], v144 offset:1280
  ds_read_b64_tr_b16 v[194:195], v144 offset:1792
  s_waitcnt lgkmcnt(10)
  v_mfma_f32_32x32x16_bf16 v[208:223], v[164:167], v[160:163], v[208:223]
  v_mfma_f32_32x32x16_bf16 v[224:239], v[168:171], v[160:163], v[224:239]
  ds_read_b128 v[196:199], v135 offset:54528
  ds_read_b64_tr_b16 v[200:201], v136 offset:60672
  ds_read_b64_tr_b16 v[202:203], v136 offset:61184
  ds_read_b64_tr_b16 v[204:205], v144 offset:3328
  ds_read_b64_tr_b16 v[206:207], v144 offset:3840
  s_waitcnt lgkmcnt(10)
  v_mfma_f32_32x32x16_bf16 v[208:223], v[176:179], v[172:175], v[208:223]
  v_mfma_f32_32x32x16_bf16 v[224:239], v[180:183], v[172:175], v[224:239]
  s_cmp_ge_u32 s5, 4
  s_cbranch_scc1 Lo_18
  s_and_b32 s14, s5, 3
  s_mul_i32 s15, s7, 4224
  s_lshl_b32 s74, s14, 10
  s_add_u32 s77, s15, 4096
  s_add_u32 s15, s15, s74
  s_mov_b32 s74, 0x05040504
  s_mov_b32 s75, 0x01000100
  s_mov_b32 s76, 0x01000504
  v_mov_b32 v84, 0
  v_mov_b32 v85, 0
  v_mov_b32 v86, 0
  v_mov_b32 v87, 0
  s_cmp_eq_u32 s14, 3
  s_cbranch_scc1 Lm3_20
  s_cmp_eq_u32 s14, 2
  s_cbranch_scc1 Lm2_19
  s_lshl_b32 s14, s14, 10
  v_subrev_u32 v28, s14, v27
  ds_read_u16 v80, v28 offset:3072
  ds_read_u16 v81, v28 offset:3088
  v_and_b32 v31, 1, v2
  v_mul_u32_u24 v31, 0x0404, v31
  v_lshlrev_b32 v31, 16, v31
  v_sub_u32 v31, 0x05040504, v31
  s_waitcnt lgkmcnt(0)
  v_perm_b32 v48, v81, v80, s74
  v_perm_b32 v49, v81, v80, v31
  v_perm_b32 v50, v81, v80, s75
  v_perm_b32 v51, v81, v80, s75
  s_branch Lme_21
Lm2_19:
  ds_read_u16 v88, v27 offset:1024
  ds_read_u16 v89, v27 offset:1032
  ds_read_u16 v90, v27 offset:1040
  s_waitcnt lgkmcnt(0)
  v_perm_b32 v48, v90, v90, s75
  v_perm_b32 v49, v89, v88, s74
  v_perm_b32 v50, v89, v88, s76
  v_perm_b32 v51, v89, v88, s75
  s_branch Lme_21
Lm3_20:
  v_cmp_gt_u32 vcc, 32, v2
  s_nop 1
  v_cndmask_b32_e64 v28, 0, 2, vcc
  v_add_u32 v29, v27, v28
  v_sub_u32 v30, v27, v28
  ds_read_u16 v92, v29 offset:14
  ds_read_u16 v93, v27 offset:12
  ds_read_u16 v94, v30 offset:10
  ds_read_u16 v95, v27 offset:8
  ds_read_u16 v96, v29 offset:6
  ds_read_u16 v97, v27 offset:4
  ds_read_u16 v98, v30 offset:2
  ds_read_u16 v99, v27 offset:0
  s_waitcnt lgkmcnt(0)
  v_lshl_or_b32 v48, v93, 16, v92
  v_lshl_or_b32 v49, v95, 16, v94
  v_lshl_or_b32 v50, v97, 16, v96
  v_lshl_or_b32 v51, v99, 16, v98
Lme_21:
  buffer_store_dwordx4 v[48:51], v26, s[52:55], s15 offen sc1
  s_mov_b64 exec, 1
  buffer_store_dwordx4 v[84:87], v26, s[52:55], s77 offen sc1
  s_mov_b64 exec, -1
Lo_18:
  s_waitcnt vmcnt(8)
  s_barrier
  s_waitcnt lgkmcnt(5)
  v_mfma_f32_32x32x16_bf16 v[208:223], v[188:191], v[184:187], v[208:223]
  v_mfma_f32_32x32x16_bf16 v[224:239], v[192:195], v[184:187], v[224:239]
  s_lshl_b32 s6, s73, 7
  s_mul_i32 s12, s73, 172032
  s_add_u32 s73, s73, 1
  s_cmp_eq_u32 s73, 7
  s_cselect_b32 s73, 0, s73
  s_add_u32 s6, s6, s42
  s_add_u32 m0, s10, 21760
  s_add_u32 s12, s12, s43
  buffer_load_dwordx4 v128, s[44:47], s6 offen lds
  ds_read_b128 v[160:163], v140 offset:21760
  ds_read_b64_tr_b16 v[164:165], v144 offset:21760
  ds_read_b64_tr_b16 v[166:167], v144 offset:22272
  ds_read_b64_tr_b16 v[168:169], v144 offset:29952
  ds_read_b64_tr_b16 v[170:171], v144 offset:30464
  s_waitcnt lgkmcnt(5)
  v_mfma_f32_32x32x16_bf16 v[208:223], v[200:203], v[196:199], v[208:223]
  v_mfma_f32_32x32x16_bf16 v[224:239], v[204:207], v[196:199], v[224:239]
  s_add_u32 m0, s11, 21760
  s_nop 0
  buffer_load_dwordx4 v130, s[48:51], s12 offen lds
  ds_read_b128 v[172:175], v141 offset:21760
  ds_read_b64_tr_b16 v[176:177], v144 offset:23808
  ds_read_b64_tr_b16 v[178:179], v144 offset:24320
  ds_read_b64_tr_b16 v[180:181], v144 offset:32000
  ds_read_b64_tr_b16 v[182:183], v144 offset:32512
  ds_read_b128 v[184:187], v142 offset:21760
  ds_read_b64_tr_b16 v[188:189], v144 offset:25856
  ds_read_b64_tr_b16 v[190:191], v144 offset:26368
  ds_read_b64_tr_b16 v[192:193], v144 offset:34048
  ds_read_b64_tr_b16 v[194:195], v144 offset:34560
  s_waitcnt lgkmcnt(10)
  v_mfma_f32_32x32x16_bf16 v[208:223], v[164:167], v[160:163], v[208:223]
  v_mfma_f32_32x32x16_bf16 v[224:239], v[168:171], v[160:163], v[224:239]
  s_add_u32 m0, s10, 22784
  s_nop 0
  buffer_load_dwordx4 v129, s[44:47], s6 offen lds
  ds_read_b128 v[196:199], v143 offset:21760
  ds_read_b64_tr_b16 v[200:201], v144 offset:27904
  ds_read_b64_tr_b16 v[202:203], v144 offset:28416
  ds_read_b64_tr_b16 v[204:205], v144 offset:36096
  ds_read_b64_tr_b16 v[206:207], v144 offset:36608
  s_waitcnt lgkmcnt(10)
  v_mfma_f32_32x32x16_bf16 v[208:223], v[176:179], v[172:175], v[208:223]
  v_mfma_f32_32x32x16_bf16 v[224:239], v[180:183], v[172:175], v[224:239]
  s_add_u32 m0, s11, 29952
  s_nop 0
  buffer_load_dwordx4 v131, s[48:51], s12 offen lds
  s_waitcnt vmcnt(4)
  s_barrier
  s_waitcnt lgkmcnt(5)
  v_mfma_f32_32x32x16_bf16 v[208:223], v[188:191], v[184:187], v[208:223]
  v_mfma_f32_32x32x16_bf16 v[224:239], v[192:195], v[184:187], v[224:239]
  s_lshl_b32 s6, s73, 7
  s_mul_i32 s12, s73, 172032
  s_add_u32 s73, s73, 1
  s_cmp_eq_u32 s73, 7
  s_cselect_b32 s73, 0, s73
  s_add_u32 s6, s6, s42
  s_add_u32 m0, s10, 54528
  s_add_u32 s12, s12, s43
  buffer_load_dwordx4 v128, s[44:47], s6 offen lds
  ds_read_b128 v[160:163], v140 offset:54528
  ds_read_b64_tr_b16 v[164:165], v144 offset:54528
  ds_read_b64_tr_b16 v[166:167], v144 offset:55040
  ds_read_b64_tr_b16 v[168:169], v144 offset:62720
  ds_read_b64_tr_b16 v[170:171], v144 offset:63232
  s_waitcnt lgkmcnt(5)
  v_mfma_f32_32x32x16_bf16 v[208:223], v[200:203], v[196:199], v[208:223]
  v_mfma_f32_32x32x16_bf16 v[224:239], v[204:207], v[196:199], v[224:239]
  s_add_u32 m0, s11, 54528
  s_nop 0
  buffer_load_dwordx4 v130, s[48:51], s12 offen lds
  ds_read_b128 v[172:175], v141 offset:54528
  ds_read_b64_tr_b16 v[176:177], v144 offset:56576
  ds_read_b64_tr_b16 v[178:179], v144 offset:57088
  ds_read_b64_tr_b16 v[180:181], v144 offset:64768
  ds_read_b64_tr_b16 v[182:183], v144 offset:65280
  ds_read_b128 v[184:187], v142 offset:54528
  ds_read_b64_tr_b16 v[188:189], v144 offset:58624
  ds_read_b64_tr_b16 v[190:191], v144 offset:59136
  ds_read_b64_tr_b16 v[192:193], v152 offset:1280
  ds_read_b64_tr_b16 v[194:195], v152 offset:1792
  s_waitcnt lgkmcnt(10)
  v_mfma_f32_32x32x16_bf16 v[208:223], v[164:167], v[160:163], v[208:223]
  v_mfma_f32_32x32x16_bf16 v[224:239], v[168:171], v[160:163], v[224:239]
  s_add_u32 m0, s10, 55552
  s_nop 0
  buffer_load_dwordx4 v129, s[44:47], s6 offen lds
  ds_read_b128 v[196:199], v143 offset:54528
  ds_read_b64_tr_b16 v[200:201], v144 offset:60672
  ds_read_b64_tr_b16 v[202:203], v144 offset:61184
  ds_read_b64_tr_b16 v[204:205], v152 offset:3328
  ds_read_b64_tr_b16 v[206:207], v152 offset:3840
  s_waitcnt lgkmcnt(10)
  v_mfma_f32_32x32x16_bf16 v[208:223], v[176:179], v[172:175], v[208:223]
  v_mfma_f32_32x32x16_bf16 v[224:239], v[180:183], v[172:175], v[224:239]
  s_add_u32 m0, s11, 62720
  s_nop 0
  buffer_load_dwordx4 v131, s[48:51], s12 offen lds
  s_waitcnt vmcnt(4)
  s_barrier
  s_cmp_ge_u32 s5, 4
  s_cbranch_scc1 Lo_22
  buffer_load_dword v145, v146, s[60:63], 0 offen sc1
Lo_22:
  s_waitcnt lgkmcnt(5)
  v_mfma_f32_32x32x16_bf16 v[208:223], v[188:191], v[184:187], v[208:223]
  v_mfma_f32_32x32x16_bf16 v[224:239], v[192:195], v[184:187], v[224:239]
  s_lshl_b32 s6, s73, 7
  s_mul_i32 s12, s73, 172032
  s_add_u32 s73, s73, 1
  s_cmp_eq_u32 s73, 7
  s_cselect_b32 s73, 0, s73
  s_add_u32 s6, s6, s42
  s_add_u32 m0, s10, 87296
  s_add_u32 s12, s12, s43
  buffer_load_dwordx4 v128, s[44:47], s6 offen lds
  ds_read_b128 v[160:163], v132 offset:21760
  ds_read_b64_tr_b16 v[164:165], v136 offset:21760
  ds_read_b64_tr_b16 v[166:167], v136 offset:22272
  ds_read_b64_tr_b16 v[168:169], v136 offset:29952
  ds_read_b64_tr_b16 v[170:171], v136 offset:30464
  s_waitcnt lgkmcnt(5)
  v_mfma_f32_32x32x16_bf16 v[208:223], v[200:203], v[196:199], v[208:223]
  v_mfma_f32_32x32x16_bf16 v[224:239], v[204:207], v[196:199], v[224:239]
  s_add_u32 m0, s11, 87296
  s_nop 0
  buffer_load_dwordx4 v130, s[48:51], s12 offen lds
  ds_read_b128 v[172:175], v133 offset:21760
  ds_read_b64_tr_b16 v[176:177], v136 offset:23808
  ds_read_b64_tr_b16 v[178:179], v136 offset:24320
  ds_read_b64_tr_b16 v[180:181], v136 offset:32000
  ds_read_b64_tr_b16 v[182:183], v136 offset:32512
  ds_read_b128 v[184:187], v134 offset:21760
  ds_read_b64_tr_b16 v[188:189], v136 offset:25856
  ds_read_b64_tr_b16 v[190:191], v136 offset:26368
  ds_read_b64_tr_b16 v[192:193], v136 offset:34048
  ds_read_b64_tr_b16 v[194:195], v136 offset:34560
  s_waitcnt lgkmcnt(10)
  v_mfma_f32_32x32x16_bf16 v[208:223], v[164:167], v[160:163], v[208:223]
  v_mfma_f32_32x32x16_bf16 v[224:239], v[168:171], v[160:163], v[224:239]
  s_add_u32 m0, s10, 88320
  s_nop 0
  buffer_load_dwordx4 v129, s[44:47], s6 offen lds
  ds_read_b128 v[196:199], v135 offset:21760
  ds_read_b64_tr_b16 v[200:201], v136 offset:27904
  ds_read_b64_tr_b16 v[202:203], v136 offset:28416
  ds_read_b64_tr_b16 v[204:205], v136 offset:36096
  ds_read_b64_tr_b16 v[206:207], v136 offset:36608
  s_waitcnt lgkmcnt(10)
  v_mfma_f32_32x32x16_bf16 v[208:223], v[176:179], v[172:175], v[208:223]
  v_mfma_f32_32x32x16_bf16 v[224:239], v[180:183], v[172:175], v[224:239]
  s_add_u32 m0, s11, 95488
  s_nop 0
  buffer_load_dwordx4 v131, s[48:51], s12 offen lds
  s_waitcnt vmcnt(4)
  s_barrier
  s_waitcnt lgkmcnt(5)
  v_mfma_f32_32x32x16_bf16 v[208:223], v[188:191], v[184:187], v[208:223]
  v_mfma_f32_32x32x16_bf16 v[224:239], v[192:195], v[184:187], v[224:239]
  ds_read_b128 v[160:163], v132 offset:54528
  ds_read_b64_tr_b16 v[164:165], v136 offset:54528
  ds_read_b64_tr_b16 v[166:167], v136 offset:55040
  ds_read_b64_tr_b16 v[168:169], v136 offset:62720
  ds_read_b64_tr_b16 v[170:171], v136 offset:63232
  s_waitcnt lgkmcnt(5)
  v_mfma_f32_32x32x16_bf16 v[208:223], v[200:203], v[196:199], v[208:223]
  v_mfma_f32_32x32x16_bf16 v[224:239], v[204:207], v[196:199], v[224:239]
  ds_read_b128 v[172:175], v133 offset:54528
  ds_read_b64_tr_b16 v[176:177], v136 offset:56576
  ds_read_b64_tr_b16 v[178:179], v136 offset:57088
  ds_read_b64_tr_b16 v[180:181], v136 offset:64768
  ds_read_b64_tr_b16 v[182:183], v136 offset:65280
  ds_read_b128 v[184:187], v134 offset:54528
  ds_read_b64_tr_b16 v[188:189], v136 offset:58624
  ds_read_b64_tr_b16 v[190:191], v136 offset:59136
  ds_read_b64_tr_b16 v[192:193], v144 offset:1280
  ds_read_b64_tr_b16 v[194:195], v144 offset:1792
  s_waitcnt lgkmcnt(10)
  v_mfma_f32_32x32x16_bf16 v[208:223], v[164:167], v[160:163], v[208:223]
  v_mfma_f32_32x32x16_bf16 v[224:239], v[168:171], v[160:163], v[224:239]
  ds_read_b128 v[196:199], v135 offset:54528
  ds_read_b64_tr_b16 v[200:201], v136 offset:60672
  ds_read_b64_tr_b16 v[202:203], v136 offset:61184
  ds_read_b64_tr_b16 v[204:205], v144 offset:3328
  ds_read_b64_tr_b16 v[206:207], v144 offset:3840
  s_waitcnt lgkmcnt(10)
  v_mfma_f32_32x32x16_bf16 v[208:223], v[176:179], v[172:175], v[208:223]
  v_mfma_f32_32x32x16_bf16 v[224:239], v[180:183], v[172:175], v[224:239]
  s_waitcnt vmcnt(0)
  s_barrier
  s_waitcnt lgkmcnt(5)
  v_mfma_f32_32x32x16_bf16 v[208:223], v[188:191], v[184:187], v[208:223]
  v_mfma_f32_32x32x16_bf16 v[224:239], v[192:195], v[184:187], v[224:239]
  ds_read_b128 v[160:163], v140 offset:21760
  ds_read_b64_tr_b16 v[164:165], v144 offset:21760
  ds_read_b64_tr_b16 v[166:167], v144 offset:22272
  ds_read_b64_tr_b16 v[168:169], v144 offset:29952
  ds_read_b64_tr_b16 v[170:171], v144 offset:30464
  s_waitcnt lgkmcnt(5)
  v_mfma_f32_32x32x16_bf16 v[208:223], v[200:203], v[196:199], v[208:223]
  v_mfma_f32_32x32x16_bf16 v[224:239], v[204:207], v[196:199], v[224:239]
  ds_read_b128 v[172:175], v141 offset:21760
  ds_read_b64_tr_b16 v[176:177], v144 offset:23808
  ds_read_b64_tr_b16 v[178:179], v144 offset:24320
  ds_read_b64_tr_b16 v[180:181], v144 offset:32000
  ds_read_b64_tr_b16 v[182:183], v144 offset:32512
  s_cmp_lg_u32 s5, 0
  s_cbranch_scc1 Lkf_23
  s_movk_i32 s64, 3000
Lwi_24:
  s_waitcnt vmcnt(0)
  v_cmp_ne_u32 vcc, 1, v145
  s_sub_u32 s64, s64, 1
  s_cbranch_scc1 Lwik_25
  s_cbranch_vccz Lwik_25
  s_sleep 2
  buffer_load_dword v145, v146, s[60:63], 0 offen sc1
  s_branch Lwi_24
Lwik_25:
  s_lshl_b32 s14, s7, 5
  s_add_u32 s14, s14, 16384
  v_mov_b32 v139, 1
  s_mov_b64 exec, 1
  buffer_store_dword v139, v138, s[56:59], s14 offen sc1
  s_mov_b64 exec, -1
Lkf_23:
  ds_read_b128 v[184:187], v142 offset:21760
  ds_read_b64_tr_b16 v[188:189], v144 offset:25856
  ds_read_b64_tr_b16 v[190:191], v144 offset:26368
  ds_read_b64_tr_b16 v[192:193], v144 offset:34048
  ds_read_b64_tr_b16 v[194:195], v144 offset:34560
  s_waitcnt lgkmcnt(10)
  v_mfma_f32_32x32x16_bf16 v[208:223], v[164:167], v[160:163], v[208:223]
  v_mfma_f32_32x32x16_bf16 v[224:239], v[168:171], v[160:163], v[224:239]
  ds_read_b128 v[196:199], v143 offset:21760
  ds_read_b64_tr_b16 v[200:201], v144 offset:27904
  ds_read_b64_tr_b16 v[202:203], v144 offset:28416
  ds_read_b64_tr_b16 v[204:205], v144 offset:36096
  ds_read_b64_tr_b16 v[206:207], v144 offset:36608
  s_waitcnt lgkmcnt(10)
  v_mfma_f32_32x32x16_bf16 v[208:223], v[176:179], v[172:175], v[208:223]
  v_mfma_f32_32x32x16_bf16 v[224:239], v[180:183], v[172:175], v[224:239]
  s_waitcnt lgkmcnt(5)
  v_mfma_f32_32x32x16_bf16 v[208:223], v[188:191], v[184:187], v[208:223]
  v_mfma_f32_32x32x16_bf16 v[224:239], v[192:195], v[184:187], v[224:239]
  s_waitcnt lgkmcnt(0)
  v_mfma_f32_32x32x16_bf16 v[208:223], v[200:203], v[196:199], v[208:223]
  v_mfma_f32_32x32x16_bf16 v[224:239], v[204:207], v[196:199], v[224:239]
  s_add_u32 s52, s40, 0x10000
  s_addc_u32 s53, s41, 0
  s_mov_b32 s54, 0x200000
  s_mov_b32 s55, 0x20000
  s_lshl_b32 s14, s8, 2
  s_and_b32 s15, s5, 3
  s_add_u32 s14, s14, s15
  s_lshl_b32 s14, s14, 4
  s_lshl_b32 s15, s9, 2
  s_add_u32 s14, s14, s15
  s_add_u32 s14, s14, s65
  s_lshl_b32 s14, s14, 11
  s_add_u32 s15, s14, 4096
  v_lshlrev_b32 v10, 4, v2
  v_cvt_pk_bf16_f32 v48, v208, v209
  v_cvt_pk_bf16_f32 v52, v210, v211
  v_and_b32 v49, 0xffff0000, v48
  v_lshlrev_b32 v48, 16, v48
  v_and_b32 v53, 0xffff0000, v52
  v_lshlrev_b32 v52, 16, v52
  v_mul_f32 v50, s66, v48
  v_mul_f32 v51, s66, v49
  v_mul_f32 v54, s66, v52
  v_mul_f32 v55, s66, v53
  v_exp_f32_e64 v50, v50 clamp
  v_exp_f32_e64 v51, v51 clamp
  v_exp_f32_e64 v54, v54 clamp
  v_exp_f32_e64 v55, v55 clamp
  v_max_f32 v48, s67, v48
  v_max_f32 v49, s67, v49
  v_max_f32 v52, s67, v52
  v_max_f32 v53, s67, v53
  v_add_f32 v48, v48, v50
  v_add_f32 v49, v49, v51
  v_add_f32 v52, v52, v54
  v_add_f32 v53, v53, v55
  v_cvt_pk_bf16_f32 v32, v48, v49
  v_cvt_pk_bf16_f32 v33, v52, v53
  v_cvt_pk_bf16_f32 v48, v212, v213
  v_cvt_pk_bf16_f32 v52, v214, v215
  v_and_b32 v49, 0xffff0000, v48
  v_lshlrev_b32 v48, 16, v48
  v_and_b32 v53, 0xffff0000, v52
  v_lshlrev_b32 v52, 16, v52
  v_mul_f32 v50, s66, v48
  v_mul_f32 v51, s66, v49
  v_mul_f32 v54, s66, v52
  v_mul_f32 v55, s66, v53
  v_exp_f32_e64 v50, v50 clamp
  v_exp_f32_e64 v51, v51 clamp
  v_exp_f32_e64 v54, v54 clamp
  v_exp_f32_e64 v55, v55 clamp
  v_max_f32 v48, s67, v48
  v_max_f32 v49, s67, v49
  v_max_f32 v52, s67, v52
  v_max_f32 v53, s67, v53
  v_add_f32 v48, v48, v50
  v_add_f32 v49, v49, v51
  v_add_f32 v52, v52, v54
  v_add_f32 v53, v53, v55
  v_cvt_pk_bf16_f32 v34, v48, v49
  v_cvt_pk_bf16_f32 v35, v52, v53
  v_cvt_pk_bf16_f32 v48, v216, v217
  v_cvt_pk_bf16_f32 v52, v218, v219
  v_and_b32 v49, 0xffff0000, v48
  v_lshlrev_b32 v48, 16, v48
  v_and_b32 v53, 0xffff0000, v52
  v_lshlrev_b32 v52, 16, v52
  v_mul_f32 v50, s66, v48
  v_mul_f32 v51, s66, v49
  v_mul_f32 v54, s66, v52
  v_mul_f32 v55, s66, v53
  v_exp_f32_e64 v50, v50 clamp
  v_exp_f32_e64 v51, v51 clamp
  v_exp_f32_e64 v54, v54 clamp
  v_exp_f32_e64 v55, v55 clamp
  v_max_f32 v48, s67, v48
  v_max_f32 v49, s67, v49
  v_max_f32 v52, s67, v52
  v_max_f32 v53, s67, v53
  v_add_f32 v48, v48, v50
  v_add_f32 v49, v49, v51
  v_add_f32 v52, v52, v54
  v_add_f32 v53, v53, v55
  v_cvt_pk_bf16_f32 v36, v48, v49
  v_cvt_pk_bf16_f32 v37, v52, v53
  v_cvt_pk_bf16_f32 v48, v220, v221
  v_cvt_pk_bf16_f32 v52, v222, v223
  v_and_b32 v49, 0xffff0000, v48
  v_lshlrev_b32 v48, 16, v48
  v_and_b32 v53, 0xffff0000, v52
  v_lshlrev_b32 v52, 16, v52
  v_mul_f32 v50, s66, v48
  v_mul_f32 v51, s66, v49
  v_mul_f32 v54, s66, v52
  v_mul_f32 v55, s66, v53
  v_exp_f32_e64 v50, v50 clamp
  v_exp_f32_e64 v51, v51 clamp
  v_exp_f32_e64 v54, v54 clamp
  v_exp_f32_e64 v55, v55 clamp
  v_max_f32 v48, s67, v48
  v_max_f32 v49, s67, v49
  v_max_f32 v52, s67, v52
  v_max_f32 v53, s67, v53
  v_add_f32 v48, v48, v50
  v_add_f32 v49, v49, v51
  v_add_f32 v52, v52, v54
  v_add_f32 v53, v53, v55
  v_cvt_pk_bf16_f32 v38, v48, v49
  v_cvt_pk_bf16_f32 v39, v52, v53
  buffer_store_dwordx4 v[32:35], v10, s[52:55], s14 offen sc1
  buffer_store_dwordx4 v[36:39], v10, s[52:55], s14 offen offset:1024 sc1
  v_cvt_pk_bf16_f32 v48, v224, v225
  v_cvt_pk_bf16_f32 v52, v226, v227
  v_and_b32 v49, 0xffff0000, v48
  v_lshlrev_b32 v48, 16, v48
  v_and_b32 v53, 0xffff0000, v52
  v_lshlrev_b32 v52, 16, v52
  v_mul_f32 v50, s66, v48
  v_mul_f32 v51, s66, v49
  v_mul_f32 v54, s66, v52
  v_mul_f32 v55, s66, v53
  v_exp_f32_e64 v50, v50 clamp
  v_exp_f32_e64 v51, v51 clamp
  v_exp_f32_e64 v54, v54 clamp
  v_exp_f32_e64 v55, v55 clamp
  v_max_f32 v48, s67, v48
  v_max_f32 v49, s67, v49
  v_max_f32 v52, s67, v52
  v_max_f32 v53, s67, v53
  v_add_f32 v48, v48, v50
  v_add_f32 v49, v49, v51
  v_add_f32 v52, v52, v54
  v_add_f32 v53, v53, v55
  v_cvt_pk_bf16_f32 v40, v48, v49
  v_cvt_pk_bf16_f32 v41, v52, v53
  v_cvt_pk_bf16_f32 v48, v228, v229
  v_cvt_pk_bf16_f32 v52, v230, v231
  v_and_b32 v49, 0xffff0000, v48
  v_lshlrev_b32 v48, 16, v48
  v_and_b32 v53, 0xffff0000, v52
  v_lshlrev_b32 v52, 16, v52
  v_mul_f32 v50, s66, v48
  v_mul_f32 v51, s66, v49
  v_mul_f32 v54, s66, v52
  v_mul_f32 v55, s66, v53
  v_exp_f32_e64 v50, v50 clamp
  v_exp_f32_e64 v51, v51 clamp
  v_exp_f32_e64 v54, v54 clamp
  v_exp_f32_e64 v55, v55 clamp
  v_max_f32 v48, s67, v48
  v_max_f32 v49, s67, v49
  v_max_f32 v52, s67, v52
  v_max_f32 v53, s67, v53
  v_add_f32 v48, v48, v50
  v_add_f32 v49, v49, v51
  v_add_f32 v52, v52, v54
  v_add_f32 v53, v53, v55
  v_cvt_pk_bf16_f32 v42, v48, v49
  v_cvt_pk_bf16_f32 v43, v52, v53
  v_cvt_pk_bf16_f32 v48, v232, v233
  v_cvt_pk_bf16_f32 v52, v234, v235
  v_and_b32 v49, 0xffff0000, v48
  v_lshlrev_b32 v48, 16, v48
  v_and_b32 v53, 0xffff0000, v52
  v_lshlrev_b32 v52, 16, v52
  v_mul_f32 v50, s66, v48
  v_mul_f32 v51, s66, v49
  v_mul_f32 v54, s66, v52
  v_mul_f32 v55, s66, v53
  v_exp_f32_e64 v50, v50 clamp
  v_exp_f32_e64 v51, v51 clamp
  v_exp_f32_e64 v54, v54 clamp
  v_exp_f32_e64 v55, v55 clamp
  v_max_f32 v48, s67, v48
  v_max_f32 v49, s67, v49
  v_max_f32 v52, s67, v52
  v_max_f32 v53, s67, v53
  v_add_f32 v48, v48, v50
  v_add_f32 v49, v49, v51
  v_add_f32 v52, v52, v54
  v_add_f32 v53, v53, v55
  v_cvt_pk_bf16_f32 v44, v48, v49
  v_cvt_pk_bf16_f32 v45, v52, v53
  v_cvt_pk_bf16_f32 v48, v236, v237
  v_cvt_pk_bf16_f32 v52, v238, v239
  v_and_b32 v49, 0xffff0000, v48
  v_lshlrev_b32 v48, 16, v48
  v_and_b32 v53, 0xffff0000, v52
  v_lshlrev_b32 v52, 16, v52
  v_mul_f32 v50, s66, v48
  v_mul_f32 v51, s66, v49
  v_mul_f32 v54, s66, v52
  v_mul_f32 v55, s66, v53
  v_exp_f32_e64 v50, v50 clamp
  v_exp_f32_e64 v51, v51 clamp
  v_exp_f32_e64 v54, v54 clamp
  v_exp_f32_e64 v55, v55 clamp
  v_max_f32 v48, s67, v48
  v_max_f32 v49, s67, v49
  v_max_f32 v52, s67, v52
  v_max_f32 v53, s67, v53
  v_add_f32 v48, v48, v50
  v_add_f32 v49, v49, v51
  v_add_f32 v52, v52, v54
  v_add_f32 v53, v53, v55
  v_cvt_pk_bf16_f32 v46, v48, v49
  v_cvt_pk_bf16_f32 v47, v52, v53
  buffer_store_dwordx4 v[40:43], v10, s[52:55], s15 offen sc1
  buffer_store_dwordx4 v[44:47], v10, s[52:55], s15 offen offset:1024 sc1
  s_lshl_b32 s14, s8, 2
  s_add_u32 s14, s14, s9
  s_lshl_b32 s14, s14, 5
  s_add_u32 s66, s14, 8192
  s_sub_u32 s4, s4, 16
  s_cmp_lt_u32 s3, 7
  s_cbranch_scc1 L_conv
  s_waitcnt vmcnt(0)
  s_barrier
  s_cmp_lg_u32 s5, 0
  s_cbranch_scc1 Lqf_26
  v_mov_b32 v139, 1
  s_mov_b64 exec, 1
  buffer_store_dword v139, v138, s[56:59], s66 offen sc1
  s_mov_b64 exec, -1
Lqf_26:
  s_endpgm
L_a:
  s_sub_u32 s6, s4, 24
  v_lshlrev_b32 v138, 2, v2
  v_and_b32 v146, 28, v138
  s_cmp_ge_u32 s5, 6
  s_cbranch_scc1 L_ut
  s_cmp_ge_u32 s5, 4
  s_cbranch_scc1 L_touch
  s_lshl_b32 s7, s3, 6
  s_add_u32 s7, s7, 32
  s_cmp_eq_u32 s3, 7
  s_cselect_b32 s7, 384, s7
  s_lshl_b32 s14, s6, 2
  s_add_u32 s7, s7, s14
  s_add_u32 s7, s7, s5
  v_lshlrev_b32 v3, 3, v2
  s_lshl_b32 s14, s7, 9
  v_add_u32 v3, s14, v3
  s_lshl_b32 s14, s7, 1
  v_mov_b32 v4, s14
  s_lshl_b32 s72, s5, 8
  s_mul_i32 s13, s5, 4736
  s_add_u32 s13, s13, 16912
  s_waitcnt lgkmcnt(0)
  global_load_dwordx2 v[148:149], v3, s[22:23]
  global_load_dwordx2 v[150:151], v3, s[24:25]
  global_load_short_d16_hi v16, v4, s[26:27]
  global_load_dwordx2 v[152:153], v3, s[18:19]
  global_load_dwordx2 v[154:155], v3, s[20:21]
  global_load_short_d16_hi v17, v4, s[28:29]
  v_mov_b32 v112, 0
  v_mov_b32 v113, 0
  v_mov_b32 v114, 0
  v_mov_b32 v115, 0
  v_mov_b32 v116, 0
  v_mov_b32 v117, 0
  v_mov_b32 v118, 0
  v_mov_b32 v119, 0
  v_mov_b32 v120, 0
  v_mov_b32 v121, 0
  v_mov_b32 v122, 0
  v_mov_b32 v123, 0
  v_mov_b32 v124, 0
  v_mov_b32 v125, 0
  v_mov_b32 v126, 0
  v_mov_b32 v127, 0
  s_mov_b32 s66, 0x3fb8aa3b
  s_mov_b32 s67, 0xbfb8aa3b
  s_mov_b32 s68, 0x3e22f983
  s_mov_b32 s69, 0x31dc9c88
  s_mov_b32 s70, 0x41000000
  s_mov_b32 s71, 0x43800000
  v_and_b32 v24, 15, v2
  v_mul_u32_u24 v20, 1056, v24
  v_lshrrev_b32 v21, 4, v2
  v_lshl_add_u32 v20, v21, 4, v20
  v_add_u32 v20, s72, v20
  v_mul_u32_u24 v21, 1056, v21
  v_lshl_add_u32 v21, v24, 4, v21
  v_mov_b32 v22, 0x00003c00
  s_add_u32 s52, s40, 0x210000
  s_addc_u32 s53, s41, 0
  s_mov_b32 s54, 0x1ce000
  s_mov_b32 s55, 0x20000
  v_lshl_add_u32 v24, v24, 4, s13
  s_mov_b32 exec_lo, 0xffff
  s_mov_b32 exec_hi, 0x0
  v_add_u32 v3, 0, v24
  v_add_u32 v4, 2, v24
  v_add_u32 v5, 4, v24
  v_add_u32 v6, 6, v24
  v_add_u32 v7, 2048, v24
  v_add_u32 v14, 2560, v24
  v_add_u32 v15, 3072, v24
  v_add_u32 v18, 3584, v24
  s_mov_b32 exec_lo, 0xffff0000
  s_mov_b32 exec_hi, 0x0
  v_add_u32 v3, 8, v24
  v_add_u32 v4, 10, v24
  v_add_u32 v5, 12, v24
  v_add_u32 v6, 14, v24
  v_add_u32 v7, 4096, v24
  v_add_u32 v14, 4098, v24
  v_add_u32 v15, 4098, v24
  v_add_u32 v18, 4098, v24
  s_mov_b32 exec_lo, 0x0
  s_mov_b32 exec_hi, 0xffff
  v_add_u32 v3, 512, v24
  v_add_u32 v4, 516, v24
  v_add_u32 v5, 520, v24
  v_add_u32 v6, 524, v24
  v_add_u32 v7, 4098, v24
  v_add_u32 v14, 4098, v24
  v_add_u32 v15, 4098, v24
  v_add_u32 v18, 4098, v24
  s_mov_b32 exec_lo, 0x0
  s_mov_b32 exec_hi, 0xffff0000
  v_add_u32 v3, 1024, v24
  v_add_u32 v4, 1032, v24
  v_add_u32 v5, 1536, v24
  v_add_u32 v6, 1544, v24
  v_add_u32 v7, 4098, v24
  v_add_u32 v14, 4098, v24
  v_add_u32 v15, 4098, v24
  v_add_u32 v18, 4098, v24
  s_mov_b64 exec, -1
  s_mov_b32 m0, s72
  s_waitcnt vmcnt(3)
  v_and_b32 v24, 0x7fff7fff, v148
  v_and_b32 v25, 0x7fff7fff, v149
  v_and_b32 v26, 0x7fff7fff, v150
  v_and_b32 v27, 0x7fff7fff, v151
  v_pk_max_u16 v24, v24, v26
  v_pk_max_u16 v25, v25, v27
  v_and_b32 v16, 0xffff0000, v16
  v_pk_max_u16 v24, v24, v25
  v_mul_f32 v16, s66, v16
  v_exp_f32 v16, v16
  v_lshrrev_b32 v25, 16, v24
  v_and_b32 v24, 0xffff, v24
  v_max_u32 v24, v24, v25
  v_cvt_pk_bf16_f32 v16, v16, v16
  v_and_b32 v16, 0xffff0000, v16
  v_max_u32_dpp v24, v24, v24 row_shr:1 row_mask:0xf bank_mask:0xf
  s_nop 1
  v_max_u32_dpp v24, v24, v24 row_shr:2 row_mask:0xf bank_mask:0xf
  s_nop 1
  v_max_u32_dpp v24, v24, v24 row_shr:4 row_mask:0xf bank_mask:0xf
  s_nop 1
  v_max_u32_dpp v24, v24, v24 row_shr:8 row_mask:0xf bank_mask:0xf
  s_nop 1
  v_max_u32_dpp v24, v24, v24 row_bcast:15 row_mask:0xa bank_mask:0xf
  s_nop 1
  v_max_u32_dpp v24, v24, v24 row_bcast:31 row_mask:0xc bank_mask:0xf
  s_nop 1
  v_readlane_b32 s74, v24, 63
  v_readfirstlane_b32 s75, v16
  s_nop 3
  s_lshr_b32 s74, s74, 7
  s_max_u32 s74, s74, 14
  s_min_u32 s74, s74, 254
  s_sub_u32 s76, 267, s74
  s_lshl_b32 s76, s76, 23
  s_sub_u32 s77, s74, 13
  s_lshl_b32 s77, s77, 23
  s_waitcnt vmcnt(0)
  s_mov_b32 s73, 4
L_apass:
  v_mov_b32 v10, v148
  v_mov_b32 v11, v150
  v_mov_b32 v8, v152
  v_mov_b32 v9, v154
  v_lshrrev_b64 v[148:149], 16, v[148:149]
  v_lshrrev_b64 v[150:151], 16, v[150:151]
  v_lshrrev_b64 v[152:153], 16, v[152:153]
  v_lshrrev_b64 v[154:155], 16, v[154:155]
  v_lshlrev_b32 v24, 16, v8
  v_lshlrev_b32 v25, 16, v9
  v_mul_f32 v24, s66, v24
  v_exp_f32 v24, v24
  v_mul_f32 v25, s75, v25
  v_mul_f32 v26, s68, v25
  v_cvt_pk_bf16_f32 v24, v24, v24
  v_fma_f32 v27, v25, s68, -v26
  v_and_b32 v24, 0xffff0000, v24
  v_fmac_f32 v27, s69, v25
  v_mul_f32 v24, s75, v24
  v_mul_f32 v24, s67, v24
  v_lshlrev_b32 v54, 16, v10
  v_lshlrev_b32 v55, 16, v11
  v_mul_f32 v54, s76, v54
  v_mul_f32 v55, s76, v55
  v_exp_f32 v28, v24
  v_mul_f32 v74, s70, v24
  v_mul_f32 v77, s71, v24
  v_fract_f32 v29, v26
  v_exp_f32 v74, v74
  v_exp_f32 v77, v77
  v_add_f32 v29, v29, v27
  v_mul_f32 v75, s70, v26
  v_mul_f32 v78, s71, v26
  v_cos_f32 v30, v29
  v_fract_f32 v75, v75
  v_fract_f32 v78, v78
  v_sin_f32 v29, v29
  v_fmac_f32 v75, s70, v27
  v_fmac_f32 v78, s71, v27
  s_nop 0
  v_cos_f32 v76, v75
  v_cos_f32 v79, v78
  v_mul_f32 v32, v28, v30
  v_sin_f32 v75, v75
  v_sin_f32 v78, v78
  v_mul_f32_e64 v33, v28, v29
  s_nop 0
  s_nop 0
  v_mul_f32 v40, v74, v76
  v_mul_f32 v38, v77, v79
  v_mul_f32_e64 v41, v74, -v75
  v_mul_f32_e64 v39, v77, v78
  v_pk_mul_f32 v[58:59], v[54:55], v[38:39] op_sel:[0,0] op_sel_hi:[1,0]
  v_pk_fma_f32 v[58:59], v[54:55], v[38:39], v[58:59] op_sel:[1,1,0] op_sel_hi:[0,1,1] neg_lo:[1,0,0]
  v_cvt_pk_f16_f32 v74, v54, v55
  v_pk_mul_f32 v[34:35], v[32:33], v[32:33] op_sel:[0,0] op_sel_hi:[1,0]
  v_cvt_pk_f16_f32 v64, v40, v41
  ds_write_addtid_b32 v74 offset:0
  v_pk_fma_f32 v[34:35], v[32:33], v[32:33], v[34:35] op_sel:[1,1,0] op_sel_hi:[0,1,1] neg_lo:[1,0,0]
  v_pk_mul_f32 v[42:43], v[40:41], v[40:41] op_sel:[0,0] op_sel_hi:[1,0]
  v_pk_mul_f32 v[56:57], v[54:55], v[32:33] op_sel:[0,0] op_sel_hi:[1,0]
  v_pk_mul_f32 v[36:37], v[34:35], v[34:35] op_sel:[0,0] op_sel_hi:[1,0]
  v_pk_fma_f32 v[42:43], v[40:41], v[40:41], v[42:43] op_sel:[1,1,0] op_sel_hi:[0,1,1] neg_lo:[1,0,0]
  v_pk_fma_f32 v[56:57], v[54:55], v[32:33], v[56:57] op_sel:[1,1,0] op_sel_hi:[0,1,1] neg_lo:[1,0,0]
  v_pk_fma_f32 v[36:37], v[34:35], v[34:35], v[36:37] op_sel:[1,1,0] op_sel_hi:[0,1,1] neg_lo:[1,0,0]
  v_cvt_pk_f16_f32 v65, v42, v43
  v_cvt_pk_f16_f32 v75, v56, v57
  v_cvt_pk_f16_f32 v76, v58, v59
  v_pk_mul_f32 v[46:47], v[42:43], v[42:43] op_sel:[0,0] op_sel_hi:[1,0]
  ds_write_addtid_b32 v75 offset:1056
  ds_write_addtid_b32 v76 offset:8448
  v_pk_fma_f32 v[46:47], v[42:43], v[42:43], v[46:47] op_sel:[1,1,0] op_sel_hi:[0,1,1] neg_lo:[1,0,0]
  v_pk_mul_f32 v[54:55], v[56:57], v[32:33] op_sel:[0,0] op_sel_hi:[1,0]
  v_pk_mul_f32 v[60:61], v[58:59], v[38:39] op_sel:[0,0] op_sel_hi:[1,0]
  v_pk_mul_f32 v[44:45], v[42:43], v[40:41] op_sel:[0,0] op_sel_hi:[1,0]
  v_pk_fma_f32 v[54:55], v[56:57], v[32:33], v[54:55] op_sel:[1,1,0] op_sel_hi:[0,1,1] neg_lo:[1,0,0]
  v_pk_fma_f32 v[60:61], v[58:59], v[38:39], v[60:61] op_sel:[1,1,0] op_sel_hi:[0,1,1] neg_lo:[1,0,0]
  v_pk_fma_f32 v[44:45], v[42:43], v[40:41], v[44:45] op_sel:[1,1,0] op_sel_hi:[0,1,1] neg_lo:[1,0,0]
  v_cvt_pk_f16_f32 v156, v54, v55
  v_pk_mul_f32 v[62:63], v[58:59], v[34:35] op_sel:[0,0] op_sel_hi:[1,0]
  v_cvt_pk_f16_f32 v67, v46, v47
  ds_write_addtid_b32 v156 offset:2112
  v_pk_fma_f32 v[62:63], v[58:59], v[34:35], v[62:63] op_sel:[1,1,0] op_sel_hi:[0,1,1] neg_lo:[1,0,0]
  v_cvt_pk_f16_f32 v66, v44, v45
  v_pk_mul_f32 v[56:57], v[54:55], v[32:33] op_sel:[0,0] op_sel_hi:[1,0]
  v_cvt_pk_f16_f32 v77, v62, v63
  v_pk_mul_f32 v[50:51], v[46:47], v[46:47] op_sel:[0,0] op_sel_hi:[1,0]
  v_pk_fma_f32 v[56:57], v[54:55], v[32:33], v[56:57] op_sel:[1,1,0] op_sel_hi:[0,1,1] neg_lo:[1,0,0]
  ds_write_addtid_b32 v77 offset:9504
  v_pk_fma_f32 v[50:51], v[46:47], v[46:47], v[50:51] op_sel:[1,1,0] op_sel_hi:[0,1,1] neg_lo:[1,0,0]
  v_cvt_pk_f16_f32 v157, v56, v57
  v_pk_mul_f32 v[12:13], v[58:59], v[36:37] op_sel:[0,0] op_sel_hi:[1,0]
  v_pk_mul_f32 v[48:49], v[46:47], v[40:41] op_sel:[0,0] op_sel_hi:[1,0]
  ds_write_addtid_b32 v157 offset:3168
  v_pk_fma_f32 v[12:13], v[58:59], v[36:37], v[12:13] op_sel:[1,1,0] op_sel_hi:[0,1,1] neg_lo:[1,0,0]
  v_pk_fma_f32 v[48:49], v[46:47], v[40:41], v[48:49] op_sel:[1,1,0] op_sel_hi:[0,1,1] neg_lo:[1,0,0]
  v_pk_mul_f32 v[54:55], v[56:57], v[32:33] op_sel:[0,0] op_sel_hi:[1,0]
  v_cvt_pk_f16_f32 v158, v12, v13
  v_cvt_pk_f16_f32 v68, v48, v49
  v_pk_fma_f32 v[54:55], v[56:57], v[32:33], v[54:55] op_sel:[1,1,0] op_sel_hi:[0,1,1] neg_lo:[1,0,0]
  ds_write_addtid_b32 v158 offset:10560
  v_pk_mul_f32 v[52:53], v[50:51], v[50:51] op_sel:[0,0] op_sel_hi:[1,0]
  v_cvt_pk_f16_f32 v74, v54, v55
  v_pk_mul_f32 v[62:63], v[12:13], v[34:35] op_sel:[0,0] op_sel_hi:[1,0]
  v_pk_fma_f32 v[52:53], v[50:51], v[50:51], v[52:53] op_sel:[1,1,0] op_sel_hi:[0,1,1] neg_lo:[1,0,0]
  ds_write_addtid_b32 v74 offset:4224
  v_pk_fma_f32 v[62:63], v[12:13], v[34:35], v[62:63] op_sel:[1,1,0] op_sel_hi:[0,1,1] neg_lo:[1,0,0]
  v_pk_mul_f32 v[48:49], v[46:47], v[42:43] op_sel:[0,0] op_sel_hi:[1,0]
  v_pk_mul_f32 v[56:57], v[54:55], v[32:33] op_sel:[0,0] op_sel_hi:[1,0]
  v_cvt_pk_f16_f32 v159, v62, v63
  v_pk_fma_f32 v[48:49], v[46:47], v[42:43], v[48:49] op_sel:[1,1,0] op_sel_hi:[0,1,1] neg_lo:[1,0,0]
  v_pk_fma_f32 v[56:57], v[54:55], v[32:33], v[56:57] op_sel:[1,1,0] op_sel_hi:[0,1,1] neg_lo:[1,0,0]
  ds_write_addtid_b32 v159 offset:11616
  v_cvt_pk_f16_f32 v69, v48, v49
  v_cvt_pk_f16_f32 v75, v56, v57
  v_cvt_pk_f16_f32 v76, v60, v61
  v_pk_mul_f32 v[48:49], v[46:47], v[44:45] op_sel:[0,0] op_sel_hi:[1,0]
  ds_write_addtid_b32 v75 offset:5280
  ds_write_addtid_b32 v76 offset:12672
  v_pk_fma_f32 v[48:49], v[46:47], v[44:45], v[48:49] op_sel:[1,1,0] op_sel_hi:[0,1,1] neg_lo:[1,0,0]
  v_pk_mul_f32 v[54:55], v[56:57], v[32:33] op_sel:[0,0] op_sel_hi:[1,0]
  v_pk_mul_f32 v[58:59], v[60:61], v[38:39] op_sel:[0,0] op_sel_hi:[1,0]
  v_cvt_pk_f16_f32 v70, v48, v49
  v_pk_fma_f32 v[54:55], v[56:57], v[32:33], v[54:55] op_sel:[1,1,0] op_sel_hi:[0,1,1] neg_lo:[1,0,0]
  v_pk_fma_f32 v[58:59], v[60:61], v[38:39], v[58:59] op_sel:[1,1,0] op_sel_hi:[0,1,1] neg_lo:[1,0,0]
  v_pk_mul_f32 v[48:49], v[52:53], v[50:51] op_sel:[0,0] op_sel_hi:[1,0]
  v_cvt_pk_f16_f32 v156, v54, v55
  v_pk_mul_f32 v[62:63], v[60:61], v[36:37] op_sel:[0,0] op_sel_hi:[1,0]
  v_pk_fma_f32 v[48:49], v[52:53], v[50:51], v[48:49] op_sel:[1,1,0] op_sel_hi:[0,1,1] neg_lo:[1,0,0]
  ds_write_addtid_b32 v156 offset:6336
  v_pk_fma_f32 v[62:63], v[60:61], v[36:37], v[62:63] op_sel:[1,1,0] op_sel_hi:[0,1,1] neg_lo:[1,0,0]
  v_cvt_pk_f16_f32 v71, v50, v51
  v_pk_mul_f32 v[56:57], v[54:55], v[32:33] op_sel:[0,0] op_sel_hi:[1,0]
  v_cvt_pk_f16_f32 v77, v62, v63
  v_cvt_pk_f16_f32 v72, v52, v53
  v_pk_fma_f32 v[56:57], v[54:55], v[32:33], v[56:57] op_sel:[1,1,0] op_sel_hi:[0,1,1] neg_lo:[1,0,0]
  ds_write_addtid_b32 v77 offset:13728
  v_cvt_pk_f16_f32 v73, v48, v49
  v_cvt_pk_f16_f32 v157, v56, v57
  v_cvt_pk_f16_f32 v158, v58, v59
  ds_write_addtid_b32 v157 offset:7392
  ds_write_addtid_b32 v158 offset:14784
  v_pk_mul_f32 v[60:61], v[58:59], v[38:39] op_sel:[0,0] op_sel_hi:[1,0]
  v_pk_fma_f32 v[60:61], v[58:59], v[38:39], v[60:61] op_sel:[1,1,0] op_sel_hi:[0,1,1] neg_lo:[1,0,0]
  v_pk_mul_f32 v[62:63], v[58:59], v[36:37] op_sel:[0,0] op_sel_hi:[1,0]
  v_pk_fma_f32 v[62:63], v[58:59], v[36:37], v[62:63] op_sel:[1,1,0] op_sel_hi:[0,1,1] neg_lo:[1,0,0]
  v_cvt_pk_f16_f32 v159, v62, v63
  ds_write_addtid_b32 v159 offset:15840
  ds_read_b128 v[80:83], v20 offset:0
  ds_read_b128 v[84:87], v20 offset:64
  ds_read_b128 v[88:91], v20 offset:128
  ds_read_b128 v[92:95], v20 offset:192
  v_cvt_pk_f16_f32 v76, v60, v61
  v_pk_mul_f16 v32, v71, v64 op_sel:[0,0] op_sel_hi:[1,0]
  ds_write_addtid_b32 v76 offset:0
  v_pk_fma_f16 v32, v71, v64, v32 op_sel:[1,1,0] op_sel_hi:[0,1,1] neg_lo:[1,0,0]
  v_pk_mul_f32 v[58:59], v[60:61], v[38:39] op_sel:[0,0] op_sel_hi:[1,0]
  v_pk_mul_f16 v33, v71, v65 op_sel:[0,0] op_sel_hi:[1,0]
  v_pk_fma_f32 v[58:59], v[60:61], v[38:39], v[58:59] op_sel:[1,1,0] op_sel_hi:[0,1,1] neg_lo:[1,0,0]
  v_pk_fma_f16 v33, v71, v65, v33 op_sel:[1,1,0] op_sel_hi:[0,1,1] neg_lo:[1,0,0]
  v_cvt_pk_f16_f32 v77, v58, v59
  v_pk_mul_f16 v34, v71, v66 op_sel:[0,0] op_sel_hi:[1,0]
  ds_write_addtid_b32 v77 offset:1056
  v_pk_fma_f16 v34, v71, v66, v34 op_sel:[1,1,0] op_sel_hi:[0,1,1] neg_lo:[1,0,0]
  v_pk_mul_f32 v[60:61], v[58:59], v[38:39] op_sel:[0,0] op_sel_hi:[1,0]
  v_pk_mul_f16 v35, v71, v67 op_sel:[0,0] op_sel_hi:[1,0]
  v_pk_fma_f32 v[60:61], v[58:59], v[38:39], v[60:61] op_sel:[1,1,0] op_sel_hi:[0,1,1] neg_lo:[1,0,0]
  v_pk_fma_f16 v35, v71, v67, v35 op_sel:[1,1,0] op_sel_hi:[0,1,1] neg_lo:[1,0,0]
  v_cvt_pk_f16_f32 v158, v60, v61
  v_pk_mul_f16 v36, v71, v68 op_sel:[0,0] op_sel_hi:[1,0]
  ds_write_addtid_b32 v158 offset:2112
  v_pk_fma_f16 v36, v71, v68, v36 op_sel:[1,1,0] op_sel_hi:[0,1,1] neg_lo:[1,0,0]
  v_pk_mul_f32 v[58:59], v[60:61], v[38:39] op_sel:[0,0] op_sel_hi:[1,0]
  v_pk_mul_f16 v37, v71, v69 op_sel:[0,0] op_sel_hi:[1,0]
  v_pk_fma_f32 v[58:59], v[60:61], v[38:39], v[58:59] op_sel:[1,1,0] op_sel_hi:[0,1,1] neg_lo:[1,0,0]
  v_pk_fma_f16 v37, v71, v69, v37 op_sel:[1,1,0] op_sel_hi:[0,1,1] neg_lo:[1,0,0]
  v_cvt_pk_f16_f32 v159, v58, v59
  v_pk_mul_f16 v40, v71, v70 op_sel:[0,0] op_sel_hi:[1,0]
  ds_write_addtid_b32 v159 offset:3168
  v_pk_fma_f16 v40, v71, v70, v40 op_sel:[1,1,0] op_sel_hi:[0,1,1] neg_lo:[1,0,0]
  v_pk_mul_f32 v[60:61], v[58:59], v[38:39] op_sel:[0,0] op_sel_hi:[1,0]
  v_pk_fma_f32 v[60:61], v[58:59], v[38:39], v[60:61] op_sel:[1,1,0] op_sel_hi:[0,1,1] neg_lo:[1,0,0]
  v_cvt_pk_f16_f32 v76, v60, v61
  ds_write_addtid_b32 v76 offset:4224
  ds_read_b128 v[96:99], v20 offset:0
  ds_read_b128 v[100:103], v20 offset:64
  ds_read_b128 v[104:107], v20 offset:128
  ds_read_b128 v[108:111], v20 offset:192
  ds_write_addtid_b32 v22 offset:0
  v_pk_mul_f16 v41, v72, v64 op_sel:[0,0] op_sel_hi:[1,0]
  ds_write_addtid_b32 v64 offset:1056
  v_pk_fma_f16 v41, v72, v64, v41 op_sel:[1,1,0] op_sel_hi:[0,1,1] neg_lo:[1,0,0]
  ds_write_addtid_b32 v65 offset:2112
  v_pk_mul_f16 v42, v72, v65 op_sel:[0,0] op_sel_hi:[1,0]
  ds_write_addtid_b32 v66 offset:3168
  v_pk_fma_f16 v42, v72, v65, v42 op_sel:[1,1,0] op_sel_hi:[0,1,1] neg_lo:[1,0,0]
  ds_write_addtid_b32 v67 offset:4224
  v_pk_mul_f16 v43, v72, v66 op_sel:[0,0] op_sel_hi:[1,0]
  ds_write_addtid_b32 v68 offset:5280
  v_pk_fma_f16 v43, v72, v66, v43 op_sel:[1,1,0] op_sel_hi:[0,1,1] neg_lo:[1,0,0]
  ds_write_addtid_b32 v69 offset:6336
  v_pk_mul_f16 v44, v72, v67 op_sel:[0,0] op_sel_hi:[1,0]
  ds_write_addtid_b32 v70 offset:7392
  v_pk_fma_f16 v44, v72, v67, v44 op_sel:[1,1,0] op_sel_hi:[0,1,1] neg_lo:[1,0,0]
  ds_write_addtid_b32 v71 offset:8448
  v_pk_mul_f16 v45, v72, v68 op_sel:[0,0] op_sel_hi:[1,0]
  ds_write_addtid_b32 v32 offset:9504
  v_pk_fma_f16 v45, v72, v68, v45 op_sel:[1,1,0] op_sel_hi:[0,1,1] neg_lo:[1,0,0]
  ds_write_addtid_b32 v33 offset:10560
  v_pk_mul_f16 v46, v72, v69 op_sel:[0,0] op_sel_hi:[1,0]
  ds_write_addtid_b32 v34 offset:11616
  v_pk_fma_f16 v46, v72, v69, v46 op_sel:[1,1,0] op_sel_hi:[0,1,1] neg_lo:[1,0,0]
  ds_write_addtid_b32 v35 offset:12672
  v_pk_mul_f16 v47, v72, v70 op_sel:[0,0] op_sel_hi:[1,0]
  ds_write_addtid_b32 v36 offset:13728
  v_pk_fma_f16 v47, v72, v70, v47 op_sel:[1,1,0] op_sel_hi:[0,1,1] neg_lo:[1,0,0]
  ds_write_addtid_b32 v37 offset:14784
  ds_write_addtid_b32 v40 offset:15840
  ds_read_b128 v[48:51], v20 offset:0
  ds_read_b128 v[52:55], v20 offset:64
  ds_read_b128 v[56:59], v20 offset:128
  ds_read_b128 v[60:63], v20 offset:192
  ds_write_addtid_b32 v72 offset:0
  v_pk_mul_f16 v75, v73, v64 op_sel:[0,0] op_sel_hi:[1,0]
  ds_write_addtid_b32 v41 offset:1056
  v_pk_fma_f16 v75, v73, v64, v75 op_sel:[1,1,0] op_sel_hi:[0,1,1] neg_lo:[1,0,0]
  ds_write_addtid_b32 v42 offset:2112
  ds_write_addtid_b32 v75 offset:9504
  ds_write_addtid_b32 v43 offset:3168
  v_pk_mul_f16 v156, v73, v65 op_sel:[0,0] op_sel_hi:[1,0]
  ds_write_addtid_b32 v44 offset:4224
  v_pk_fma_f16 v156, v73, v65, v156 op_sel:[1,1,0] op_sel_hi:[0,1,1] neg_lo:[1,0,0]
  ds_write_addtid_b32 v45 offset:5280
  ds_write_addtid_b32 v156 offset:10560
  ds_write_addtid_b32 v46 offset:6336
  v_pk_mul_f16 v157, v73, v66 op_sel:[0,0] op_sel_hi:[1,0]
  ds_write_addtid_b32 v47 offset:7392
  v_pk_fma_f16 v157, v73, v66, v157 op_sel:[1,1,0] op_sel_hi:[0,1,1] neg_lo:[1,0,0]
  ds_write_addtid_b32 v73 offset:8448
  ds_write_addtid_b32 v157 offset:11616
  v_pk_mul_f16 v74, v73, v67 op_sel:[0,0] op_sel_hi:[1,0]
  v_pk_fma_f16 v74, v73, v67, v74 op_sel:[1,1,0] op_sel_hi:[0,1,1] neg_lo:[1,0,0]
  ds_write_addtid_b32 v74 offset:12672
  v_pk_mul_f16 v75, v73, v68 op_sel:[0,0] op_sel_hi:[1,0]
  v_pk_fma_f16 v75, v73, v68, v75 op_sel:[1,1,0] op_sel_hi:[0,1,1] neg_lo:[1,0,0]
  ds_write_addtid_b32 v75 offset:13728
  v_pk_mul_f16 v156, v73, v69 op_sel:[0,0] op_sel_hi:[1,0]
  v_pk_fma_f16 v156, v73, v69, v156 op_sel:[1,1,0] op_sel_hi:[0,1,1] neg_lo:[1,0,0]
  ds_write_addtid_b32 v156 offset:14784
  v_pk_mul_f16 v157, v73, v70 op_sel:[0,0] op_sel_hi:[1,0]
  v_pk_fma_f16 v157, v73, v70, v157 op_sel:[1,1,0] op_sel_hi:[0,1,1] neg_lo:[1,0,0]
  ds_write_addtid_b32 v157 offset:15840
  ds_read_b128 v[32:35], v20 offset:0
  ds_read_b128 v[36:39], v20 offset:64
  ds_read_b128 v[40:43], v20 offset:128
  ds_read_b128 v[44:47], v20 offset:192
  s_waitcnt lgkmcnt(15)
  v_mfma_f32_16x16x32_f16 v[112:115], v[80:83], v[48:51], v[112:115]
  v_mfma_f32_16x16x32_f16 v[120:123], v[96:99], v[48:51], v[120:123]
  v_mfma_f32_16x16x32_f16 v[112:115], v[84:87], v[52:55], v[112:115]
  v_mfma_f32_16x16x32_f16 v[120:123], v[100:103], v[52:55], v[120:123]
  v_mfma_f32_16x16x32_f16 v[112:115], v[88:91], v[56:59], v[112:115]
  v_mfma_f32_16x16x32_f16 v[120:123], v[104:107], v[56:59], v[120:123]
  v_mfma_f32_16x16x32_f16 v[112:115], v[92:95], v[60:63], v[112:115]
  v_mfma_f32_16x16x32_f16 v[120:123], v[108:111], v[60:63], v[120:123]
  s_waitcnt lgkmcnt(3)
  v_mfma_f32_16x16x32_f16 v[116:119], v[80:83], v[32:35], v[116:119]
  v_mfma_f32_16x16x32_f16 v[124:127], v[96:99], v[32:35], v[124:127]
  s_waitcnt lgkmcnt(2)
  v_mfma_f32_16x16x32_f16 v[116:119], v[84:87], v[36:39], v[116:119]
  v_mfma_f32_16x16x32_f16 v[124:127], v[100:103], v[36:39], v[124:127]
  s_waitcnt lgkmcnt(1)
  v_mfma_f32_16x16x32_f16 v[116:119], v[88:91], v[40:43], v[116:119]
  v_mfma_f32_16x16x32_f16 v[124:127], v[104:107], v[40:43], v[124:127]
  s_waitcnt lgkmcnt(0)
  v_mfma_f32_16x16x32_f16 v[116:119], v[92:95], v[44:47], v[116:119]
  v_mfma_f32_16x16x32_f16 v[124:127], v[108:111], v[44:47], v[124:127]
  s_sub_u32 s73, s73, 1
  s_cmp_lg_u32 s73, 0
  s_cbranch_scc1 L_apass
  v_mov_b32 v25, s75
  v_mul_f32 v25, s77, v25
  v_add_f32 v25, v25, v25
  v_add_u32 v30, s72, v21
  v_lshlrev_b32 v26, 4, v2
  v_and_b32 v17, 0xffff0000, v17
  s_add_u32 s14, s13, 1008
  v_sub_u32 v27, s14, v26
  s_nop 1
  v_mul_f32 v112, v25, v112
  v_mul_f32 v113, v25, v113
  v_mul_f32 v114, v25, v114
  v_mul_f32 v115, v25, v115
  v_mul_f32 v116, v25, v116
  v_mul_f32 v117, v25, v117
  v_mul_f32 v118, v25, v118
  v_mul_f32 v119, v25, v119
  v_mul_f32 v120, v25, v120
  v_mul_f32 v121, v25, v121
  v_mul_f32 v122, v25, v122
  v_mul_f32 v123, v25, v123
  v_mul_f32 v124, v25, v124
  v_mul_f32 v125, v25, v125
  v_mul_f32 v126, v25, v126
  v_mul_f32 v127, v25, v127
  s_mov_b64 exec, 1
  v_add_f32 v112, v112, v17
  s_mov_b64 exec, -1
  v_cvt_pk_bf16_f32 v40, v112, v116
  ds_write_b16 v3, v40
  ds_write_b16_d16_hi v3, v40 offset:256
  v_cvt_pk_bf16_f32 v41, v113, v117
  ds_write_b16 v4, v41
  ds_write_b16_d16_hi v4, v41 offset:256
  v_cvt_pk_bf16_f32 v42, v114, v118
  ds_write_b16 v5, v42
  ds_write_b16_d16_hi v5, v42 offset:256
  v_cvt_pk_bf16_f32 v43, v115, v119
  ds_write_b16 v6, v43
  ds_write_b16_d16_hi v6, v43 offset:256
  v_cvt_pk_bf16_f32 v44, v120, v124
  ds_write_b16 v7, v44
  ds_write_b16_d16_hi v7, v44 offset:256
  v_cvt_pk_bf16_f32 v45, v121, v125
  ds_write_b16 v14, v45
  ds_write_b16_d16_hi v14, v45 offset:256
  v_cvt_pk_bf16_f32 v46, v122, v126
  ds_write_b16 v15, v46
  ds_write_b16_d16_hi v15, v46 offset:256
  v_cvt_pk_bf16_f32 v47, v123, v127
  ds_write_b16 v18, v47
  ds_write_b16_d16_hi v18, v47 offset:256
  v_cmp_gt_u32 vcc, 32, v2
  v_and_b32 v31, 1, v2
  v_mul_u32_u24 v31, 0x0404, v31
  v_cndmask_b32_e64 v28, 0, 2, vcc
  v_add_u32 v29, v27, v28
  v_sub_u32 v30, v27, v28
  ds_read_u16 v80, v27 offset:3072
  ds_read_u16 v81, v27 offset:3088
  ds_read_u16 v82, v27 offset:2048
  ds_read_u16 v83, v27 offset:2064
  ds_read_u16 v88, v27 offset:1024
  ds_read_u16 v89, v27 offset:1032
  ds_read_u16 v90, v27 offset:1040
  ds_read_u16 v92, v29 offset:14
  ds_read_u16 v93, v27 offset:12
  ds_read_u16 v94, v30 offset:10
  ds_read_u16 v95, v27 offset:8
  ds_read_u16 v96, v29 offset:6
  ds_read_u16 v97, v27 offset:4
  ds_read_u16 v98, v30 offset:2
  ds_read_u16 v99, v27 offset:0
  s_mov_b32 s60, 0x05040504
  s_mov_b32 s61, 0x01000100
  s_mov_b32 s62, 0x01000504
  s_mul_i32 s15, s7, 4224
  v_mov_b32 v84, 0
  v_mov_b32 v85, 0
  v_mov_b32 v86, 0
  v_mov_b32 v87, 0
  v_lshlrev_b32 v31, 16, v31
  v_sub_u32 v31, 0x05040504, v31
  s_waitcnt lgkmcnt(8)
  v_perm_b32 v48, v81, v80, s60
  v_perm_b32 v49, v81, v80, v31
  v_perm_b32 v50, v81, v80, s61
  v_perm_b32 v51, v81, v80, s61
  buffer_store_dwordx4 v[48:51], v26, s[52:55], s15 offen offset:0 sc1
  v_perm_b32 v52, v83, v82, s60
  v_perm_b32 v53, v83, v82, v31
  v_perm_b32 v54, v83, v82, s61
  v_perm_b32 v55, v83, v82, s61
  buffer_store_dwordx4 v[52:55], v26, s[52:55], s15 offen offset:1024 sc1
  v_perm_b32 v56, v90, v90, s61
  v_perm_b32 v57, v89, v88, s60
  v_perm_b32 v58, v89, v88, s62
  v_perm_b32 v59, v89, v88, s61
  buffer_store_dwordx4 v[56:59], v26, s[52:55], s15 offen offset:2048 sc1
  s_waitcnt lgkmcnt(0)
  v_lshl_or_b32 v60, v93, 16, v92
  v_lshl_or_b32 v61, v95, 16, v94
  v_lshl_or_b32 v62, v97, 16, v96
  v_lshl_or_b32 v63, v99, 16, v98
  buffer_store_dwordx4 v[60:63], v26, s[52:55], s15 offen offset:3072 sc1
  s_add_u32 s15, s15, 4096
  s_mov_b64 exec, 1
  buffer_store_dwordx4 v[84:87], v26, s[52:55], s15 offen sc1
  s_mov_b64 exec, -1
  s_add_u32 s56, s40, 0x800000
  s_addc_u32 s57, s41, 0
  s_mov_b32 s58, 0x8000
  s_mov_b32 s59, 0x20000
  s_mov_b32 s60, s38
  s_mov_b32 s61, s39
  s_mov_b32 s62, 0x100
  s_mov_b32 s63, 0x20000
  s_movk_i32 s64, 3000
  buffer_load_dword v145, v146, s[60:63], 0 offen sc1
Lwi_27:
  s_waitcnt vmcnt(0)
  v_cmp_ne_u32 vcc, 1, v145
  s_sub_u32 s64, s64, 1
  s_cbranch_scc1 Lwik_28
  s_cbranch_vccz Lwik_28
  s_sleep 2
  buffer_load_dword v145, v146, s[60:63], 0 offen sc1
  s_branch Lwi_27
Lwik_28:
  s_lshl_b32 s14, s7, 5
  s_add_u32 s14, s14, 16384
  v_mov_b32 v139, 1
  s_mov_b64 exec, 1
  buffer_store_dword v139, v138, s[56:59], s14 offen sc1
  s_mov_b64 exec, -1
  s_branch L_a_done
L_touch:
  s_setprio 3
  s_lshl_b32 s8, s6, 1
  s_add_u32 s8, s8, s5
  s_sub_u32 s8, s8, 4
  v_mul_u32_u24 v5, 43, v2
  v_lshrrev_b32 v5, 9, v5
  v_mul_u32_u24 v6, 12, v5
  v_sub_u32 v6, v2, v6
  s_lshl_b32 s9, s8, 2
  v_add_u32 v5, s9, v5
  v_mul_u32_u24 v5, 2688, v5
  v_lshl_add_u32 v5, v6, 7, v5
  v_lshrrev_b32 v6, 2, v6
  v_mul_u32_u24 v6, 384, v6
  v_add_u32 v5, v5, v6
  s_and_b32 s9, s3, 1
  s_mul_i32 s9, s9, 384
  s_add_u32 s9, s9, 344064
  s_lshl_b32 s10, s8, 5
  s_lshr_b32 s11, s3, 1
  s_lshl_b32 s11, s11, 9
  s_add_u32 s10, s10, s11
  v_add_u32 v6, s10, v2
  v_mul_u32_u24 v6, 896, v6
  s_movk_i32 s10, 256
  s_waitcnt lgkmcnt(0)
  s_mov_b32 s44, s30
  s_mov_b32 s45, s31
  s_mov_b32 s46, 0x1c0000
  s_mov_b32 s47, 0x20000
  s_mov_b32 s48, s32
  s_mov_b32 s49, s33
  s_mov_b32 s50, 0x126000
  s_mov_b32 s51, 0x20000
  s_mov_b32 exec_hi, 0xffff
  buffer_load_dword v13, v5, s[48:51], s9 offen
  s_mov_b32 exec_hi, 0
  buffer_load_dword v13, v6, s[44:47], s10 offen
  s_add_u32 s9, s9, 172032
  s_add_u32 s10, s10, 128
  s_mov_b32 exec_hi, 0xffff
  buffer_load_dword v13, v5, s[48:51], s9 offen
  s_mov_b32 exec_hi, 0
  buffer_load_dword v13, v6, s[44:47], s10 offen
  s_add_u32 s9, s9, 172032
  s_add_u32 s10, s10, 128
  s_waitcnt vmcnt(2)
  s_mov_b32 exec_hi, 0xffff
  buffer_load_dword v13, v5, s[48:51], s9 offen
  s_mov_b32 exec_hi, 0
  buffer_load_dword v13, v6, s[44:47], s10 offen
  s_add_u32 s9, s9, 172032
  s_add_u32 s10, s10, 128
  s_waitcnt vmcnt(2)
  s_mov_b32 exec_hi, 0xffff
  buffer_load_dword v13, v5, s[48:51], s9 offen
  s_mov_b32 exec_hi, 0
  buffer_load_dword v13, v6, s[44:47], s10 offen
  s_add_u32 s9, s9, 172032
  s_add_u32 s10, s10, 128
  s_waitcnt vmcnt(2)
  s_mov_b32 exec_hi, 0xffff
  buffer_load_dword v13, v5, s[48:51], s9 offen
  s_mov_b32 exec_hi, 0
  buffer_load_dword v13, v6, s[44:47], s10 offen
  s_add_u32 s9, s9, 172032
  s_add_u32 s10, s10, 128
  s_mov_b64 exec, -1
  s_mov_b32 s48, s34
  s_mov_b32 s49, s35
  s_mov_b32 s50, 0x62000
  s_mov_b32 s51, 0x20000
  s_mul_i32 s9, s8, 25088
  v_lshlrev_b32 v5, 7, v2
  s_waitcnt vmcnt(2)
  buffer_load_dword v13, v5, s[48:51], s9 offen
  s_add_u32 s9, s9, 8192
  buffer_load_dword v13, v5, s[48:51], s9 offen
  s_add_u32 s9, s9, 8192
  buffer_load_dword v13, v5, s[48:51], s9 offen
  s_add_u32 s9, s9, 8192
  s_mov_b64 exec, 15
  buffer_load_dword v13, v5, s[48:51], s9 offen
  s_add_u32 s9, s9, 8192
  s_mov_b64 exec, -1
  s_setprio 0
  s_branch L_a_done
L_ut:
  s_sub_u32 s7, s5, 6
  s_lshl_b32 s9, s3, 3
  s_add_u32 s9, s9, s6
  s_lshl_b32 s9, s9, 1
  s_add_u32 s9, s9, s7
  s_mul_i32 s10, s9, 14336
  s_mul_i32 s11, s7, 14336
  s_add_u32 s11, s11, 36864
  v_lshlrev_b32 v4, 4, v2
  v_mov_b32 v8, 0
  v_mov_b32 v9, 0
  v_mov_b32 v10, 0
  v_mov_b32 v11, 0
  s_waitcnt lgkmcnt(0)
  s_mov_b32 s44, s16
  s_mov_b32 s45, s17
  s_mov_b32 s46, 0x1c0000
  s_mov_b32 s47, 0x20000
  s_add_u32 s48, s40, 0x600000
  s_addc_u32 s49, s41, 0
  s_mov_b32 s50, 0x1c0000
  s_mov_b32 s51, 0x20000
  s_mov_b32 s52, s40
  s_mov_b32 s53, s41
  s_mov_b32 s54, 0x10000
  s_mov_b32 s55, 0x20000
  s_add_u32 s56, s40, 0x800000
  s_addc_u32 s57, s41, 0
  s_mov_b32 s58, 0x8000
  s_mov_b32 s59, 0x20000
  s_mov_b32 s60, s38
  s_mov_b32 s61, s39
  s_mov_b32 s62, 0x100
  s_mov_b32 s63, 0x20000
  s_cmp_lg_u32 s6, 1
  s_cbranch_scc1 Lnz_29
  s_cmp_lg_u32 s7, 0
  s_cbranch_scc1 Lnz_29
  s_lshl_b32 s12, s3, 13
  buffer_store_dwordx4 v[8:11], v4, s[52:55], s12 offen offset:0 sc1
  buffer_store_dwordx4 v[8:11], v4, s[52:55], s12 offen offset:1024 sc1
  buffer_store_dwordx4 v[8:11], v4, s[52:55], s12 offen offset:2048 sc1
  buffer_store_dwordx4 v[8:11], v4, s[52:55], s12 offen offset:3072 sc1
  s_add_u32 s12, s12, 4096
  buffer_store_dwordx4 v[8:11], v4, s[52:55], s12 offen offset:0 sc1
  buffer_store_dwordx4 v[8:11], v4, s[52:55], s12 offen offset:1024 sc1
  buffer_store_dwordx4 v[8:11], v4, s[52:55], s12 offen offset:2048 sc1
  buffer_store_dwordx4 v[8:11], v4, s[52:55], s12 offen offset:3072 sc1
  s_lshl_b32 s12, s3, 12
  v_lshlrev_b32 v12, 5, v2
  buffer_store_dword v8, v12, s[56:59], s12 offen sc1
  s_add_u32 s12, s12, 2048
  buffer_store_dword v8, v12, s[56:59], s12 offen sc1
  s_waitcnt vmcnt(0)
  v_mov_b32 v12, 1
  s_lshl_b32 s12, s3, 2
  s_mov_b64 exec, 1
  buffer_store_dword v12, v8, s[60:63], s12 offen sc1
  s_mov_b64 exec, -1
Lnz_29:
  s_add_u32 m0, s11, 0
  s_nop 0
  buffer_load_dwordx4 v4, s[44:47], s10 offen lds
  s_add_u32 s10, s10, 1024
  s_add_u32 m0, s11, 1024
  s_nop 0
  buffer_load_dwordx4 v4, s[44:47], s10 offen lds
  s_add_u32 s10, s10, 1024
  s_add_u32 m0, s11, 2048
  s_nop 0
  buffer_load_dwordx4 v4, s[44:47], s10 offen lds
  s_add_u32 s10, s10, 1024
  s_add_u32 m0, s11, 3072
  s_nop 0
  buffer_load_dwordx4 v4, s[44:47], s10 offen lds
  s_add_u32 s10, s10, 1024
  s_add_u32 m0, s11, 4096
  s_nop 0
  buffer_load_dwordx4 v4, s[44:47], s10 offen lds
  s_add_u32 s10, s10, 1024
  s_add_u32 m0, s11, 5120
  s_nop 0
  buffer_load_dwordx4 v4, s[44:47], s10 offen lds
  s_add_u32 s10, s10, 1024
  s_add_u32 m0, s11, 6144
  s_nop 0
  buffer_load_dwordx4 v4, s[44:47], s10 offen lds
  s_add_u32 s10, s10, 1024
  s_add_u32 m0, s11, 7168
  s_nop 0
  buffer_load_dwordx4 v4, s[44:47], s10 offen lds
  s_add_u32 s10, s10, 1024
  s_add_u32 m0, s11, 8192
  s_nop 0
  buffer_load_dwordx4 v4, s[44:47], s10 offen lds
  s_add_u32 s10, s10, 1024
  s_add_u32 m0, s11, 9216
  s_nop 0
  buffer_load_dwordx4 v4, s[44:47], s10 offen lds
  s_add_u32 s10, s10, 1024
  s_add_u32 m0, s11, 10240
  s_nop 0
  buffer_load_dwordx4 v4, s[44:47], s10 offen lds
  s_add_u32 s10, s10, 1024
  s_add_u32 m0, s11, 11264
  s_nop 0
  buffer_load_dwordx4 v4, s[44:47], s10 offen lds
  s_add_u32 s10, s10, 1024
  s_add_u32 m0, s11, 12288
  s_nop 0
  buffer_load_dwordx4 v4, s[44:47], s10 offen lds
  s_add_u32 s10, s10, 1024
  s_add_u32 m0, s11, 13312
  s_nop 0
  buffer_load_dwordx4 v4, s[44:47], s10 offen lds
  s_add_u32 s10, s10, 1024
  v_bfe_u32 v5, v2, 2, 2
  v_and_b32 v6, 1, v2
  v_lshl_add_u32 v5, v6, 3, v5
  v_mul_u32_u24 v5, 896, v5
  v_lshrrev_b32 v6, 4, v2
  v_lshl_add_u32 v5, v6, 4, v5
  v_bfe_u32 v6, v2, 1, 1
  v_lshl_add_u32 v5, v6, 3, v5
  v_add_u32 v5, s11, v5
  v_lshrrev_b32 v7, 3, v2
  v_lshlrev_b32 v7, 14, v7
  v_and_b32 v6, 7, v2
  v_lshl_add_u32 v7, v6, 4, v7
  s_lshl_b32 s10, s9, 7
  s_waitcnt vmcnt(0)
  ds_read_b64_tr_b16 v[32:33], v5 offset:0
  ds_read_b64_tr_b16 v[34:35], v5 offset:3584
  ds_read_b64_tr_b16 v[36:37], v5 offset:64
  ds_read_b64_tr_b16 v[38:39], v5 offset:3648
  ds_read_b64_tr_b16 v[40:41], v5 offset:128
  ds_read_b64_tr_b16 v[42:43], v5 offset:3712
  ds_read_b64_tr_b16 v[44:45], v5 offset:192
  ds_read_b64_tr_b16 v[46:47], v5 offset:3776
  ds_read_b64_tr_b16 v[48:49], v5 offset:256
  ds_read_b64_tr_b16 v[50:51], v5 offset:3840
  ds_read_b64_tr_b16 v[52:53], v5 offset:320
  ds_read_b64_tr_b16 v[54:55], v5 offset:3904
  ds_read_b64_tr_b16 v[56:57], v5 offset:384
  ds_read_b64_tr_b16 v[58:59], v5 offset:3968
  s_waitcnt lgkmcnt(4)
  ds_read_b64_tr_b16 v[60:61], v5 offset:448
  ds_read_b64_tr_b16 v[62:63], v5 offset:4032
  ds_read_b64_tr_b16 v[64:65], v5 offset:512
  ds_read_b64_tr_b16 v[66:67], v5 offset:4096
  ds_read_b64_tr_b16 v[68:69], v5 offset:576
  ds_read_b64_tr_b16 v[70:71], v5 offset:4160
  ds_read_b64_tr_b16 v[72:73], v5 offset:640
  ds_read_b64_tr_b16 v[74:75], v5 offset:4224
  ds_read_b64_tr_b16 v[76:77], v5 offset:704
  ds_read_b64_tr_b16 v[78:79], v5 offset:4288
  ds_read_b64_tr_b16 v[80:81], v5 offset:768
  ds_read_b64_tr_b16 v[82:83], v5 offset:4352
  ds_read_b64_tr_b16 v[84:85], v5 offset:832
  ds_read_b64_tr_b16 v[86:87], v5 offset:4416
  buffer_store_dwordx4 v[32:35], v7, s[48:51], s10 offen sc1
  s_add_u32 s10, s10, 131072
  buffer_store_dwordx4 v[36:39], v7, s[48:51], s10 offen sc1
  s_add_u32 s10, s10, 131072
  buffer_store_dwordx4 v[40:43], v7, s[48:51], s10 offen sc1
  s_add_u32 s10, s10, 131072
  buffer_store_dwordx4 v[44:47], v7, s[48:51], s10 offen sc1
  s_add_u32 s10, s10, 131072
  buffer_store_dwordx4 v[48:51], v7, s[48:51], s10 offen sc1
  s_add_u32 s10, s10, 131072
  s_waitcnt lgkmcnt(14)
  buffer_store_dwordx4 v[52:55], v7, s[48:51], s10 offen sc1
  s_add_u32 s10, s10, 131072
  buffer_store_dwordx4 v[56:59], v7, s[48:51], s10 offen sc1
  s_add_u32 s10, s10, 131072
  s_waitcnt lgkmcnt(12)
  buffer_store_dwordx4 v[60:63], v7, s[48:51], s10 offen sc1
  s_add_u32 s10, s10, 131072
  s_waitcnt lgkmcnt(10)
  buffer_store_dwordx4 v[64:67], v7, s[48:51], s10 offen sc1
  s_add_u32 s10, s10, 131072
  s_waitcnt lgkmcnt(8)
  buffer_store_dwordx4 v[68:71], v7, s[48:51], s10 offen sc1
  s_add_u32 s10, s10, 131072
  s_waitcnt lgkmcnt(6)
  buffer_store_dwordx4 v[72:75], v7, s[48:51], s10 offen sc1
  s_add_u32 s10, s10, 131072
  s_waitcnt lgkmcnt(4)
  buffer_store_dwordx4 v[76:79], v7, s[48:51], s10 offen sc1
  s_add_u32 s10, s10, 131072
  s_waitcnt lgkmcnt(2)
  buffer_store_dwordx4 v[80:83], v7, s[48:51], s10 offen sc1
  s_add_u32 s10, s10, 131072
  s_waitcnt lgkmcnt(0)
  buffer_store_dwordx4 v[84:87], v7, s[48:51], s10 offen sc1
  s_add_u32 s10, s10, 131072
  s_movk_i32 s64, 3000
  buffer_load_dword v145, v146, s[60:63], 0 offen sc1
Lwi_30:
  s_waitcnt vmcnt(0)
  v_cmp_ne_u32 vcc, 1, v145
  s_sub_u32 s64, s64, 1
  s_cbranch_scc1 Lwik_31
  s_cbranch_vccz Lwik_31
  s_sleep 2
  buffer_load_dword v145, v146, s[60:63], 0 offen sc1
  s_branch Lwi_30
Lwik_31:
  s_lshl_b32 s14, s9, 5
  v_mov_b32 v139, 1
  s_mov_b64 exec, 1
  buffer_store_dword v139, v138, s[56:59], s14 offen sc1
  s_mov_b64 exec, -1
L_a_done:
  s_add_u32 s4, s6, 8
  s_mov_b32 s66, 0
  s_cmp_lt_u32 s3, 7
  s_cbranch_scc1 L_conv
  s_endpgm
L_w4:
  s_mov_b32 s6, s4
  s_cmp_ge_u32 s6, 7
  s_cselect_b32 s7, 1, 0
  s_lshl_b32 s8, s3, 1
  s_add_u32 s8, s8, s7
  s_mul_i32 s7, s7, 7
  s_sub_u32 s9, s6, s7
  s_and_b32 s10, s5, 3
  s_lshr_b32 s11, s5, 2
  s_mov_b32 s44, s40
  s_mov_b32 s45, s41
  s_mov_b32 s46, 0x10000
  s_mov_b32 s47, 0x20000
  s_add_u32 s48, s40, 0x10000
  s_addc_u32 s49, s41, 0
  s_mov_b32 s50, 0x200000
  s_mov_b32 s51, 0x20000
  s_mov_b32 s52, s34
  s_mov_b32 s53, s35
  s_mov_b32 s54, 0x62000
  s_mov_b32 s55, 0x20000
  s_mov_b32 s56, s36
  s_mov_b32 s57, s37
  s_mov_b32 s58, 0x380000
  s_mov_b32 s59, 0x20000
  s_add_u32 s68, s40, 0x800000
  s_addc_u32 s69, s41, 0
  s_mov_b32 s70, 0x8000
  s_mov_b32 s71, 0x20000
  v_lshrrev_b32 v5, 3, v2
  v_bfe_u32 v6, v2, 4, 1
  v_lshlrev_b32 v6, 2, v6
  v_and_b32 v7, 7, v2
  v_xor_b32 v6, v6, v7
  v_lshlrev_b32 v6, 4, v6
  s_mul_i32 s60, s10, 112
  s_mul_i32 s61, s11, 14
  s_add_u32 s60, s60, s61
  s_mul_i32 s60, s60, 896
  s_lshl_b32 s61, s9, 7
  s_add_u32 s60, s60, s61
  s_mul_i32 s61, s5, 7168
  v_add_u32 v7, 0, v5
  v_mul_u32_u24 v15, 37, v7
  v_lshrrev_b32 v15, 9, v15
  v_mad_u32_u24 v7, v15, 14, v7
  v_mul_u32_u24 v7, 896, v7
  v_add_u32 v7, v7, v6
  s_add_u32 m0, s61, 0
  s_nop 0
  buffer_load_dwordx4 v7, s[52:55], s60 offen lds
  v_add_u32 v7, 8, v5
  v_mul_u32_u24 v15, 37, v7
  v_lshrrev_b32 v15, 9, v15
  v_mad_u32_u24 v7, v15, 14, v7
  v_mul_u32_u24 v7, 896, v7
  v_add_u32 v7, v7, v6
  s_add_u32 m0, s61, 1024
  s_nop 0
  buffer_load_dwordx4 v7, s[52:55], s60 offen lds
  v_add_u32 v7, 16, v5
  v_mul_u32_u24 v15, 37, v7
  v_lshrrev_b32 v15, 9, v15
  v_mad_u32_u24 v7, v15, 14, v7
  v_mul_u32_u24 v7, 896, v7
  v_add_u32 v7, v7, v6
  s_add_u32 m0, s61, 2048
  s_nop 0
  buffer_load_dwordx4 v7, s[52:55], s60 offen lds
  v_add_u32 v7, 24, v5
  v_mul_u32_u24 v15, 37, v7
  v_lshrrev_b32 v15, 9, v15
  v_mad_u32_u24 v7, v15, 14, v7
  v_mul_u32_u24 v7, 896, v7
  v_add_u32 v7, v7, v6
  s_add_u32 m0, s61, 3072
  s_nop 0
  buffer_load_dwordx4 v7, s[52:55], s60 offen lds
  v_add_u32 v7, 32, v5
  v_mul_u32_u24 v15, 37, v7
  v_lshrrev_b32 v15, 9, v15
  v_mad_u32_u24 v7, v15, 14, v7
  v_mul_u32_u24 v7, 896, v7
  v_add_u32 v7, v7, v6
  s_add_u32 m0, s61, 4096
  s_nop 0
  buffer_load_dwordx4 v7, s[52:55], s60 offen lds
  v_add_u32 v7, 40, v5
  v_mul_u32_u24 v15, 37, v7
  v_lshrrev_b32 v15, 9, v15
  v_mad_u32_u24 v7, v15, 14, v7
  v_mul_u32_u24 v7, 896, v7
  v_add_u32 v7, v7, v6
  s_add_u32 m0, s61, 5120
  s_nop 0
  buffer_load_dwordx4 v7, s[52:55], s60 offen lds
  v_add_u32 v7, 48, v5
  v_mul_u32_u24 v15, 37, v7
  v_lshrrev_b32 v15, 9, v15
  v_mad_u32_u24 v7, v15, 14, v7
  v_mul_u32_u24 v7, 896, v7
  v_add_u32 v7, v7, v6
  s_add_u32 m0, s61, 6144
  s_nop 0
  buffer_load_dwordx4 v7, s[52:55], s60 offen lds
  v_and_b32 v4, 3, v2
  v_lshlrev_b32 v8, 5, v4
  v_bfe_u32 v5, v2, 3, 2
  v_lshl_add_u32 v4, v5, 2, v4
  v_bfe_u32 v5, v2, 2, 1
  v_add_u32 v6, 2, v4
  v_lshrrev_b32 v6, 4, v6
  v_or_b32 v5, v5, v6
  v_mad_u32_u24 v4, v5, 14, v4
  v_and_b32 v5, 32, v2
  v_add_lshl_u32 v3, v4, v5, 4
  v_lshlrev_b32 v4, 4, v2
  v_lshlrev_b32 v9, 5, v2
  s_lshl_b32 s12, s5, 13
  s_add_u32 s13, s12, 4096
  s_lshl_b32 s14, s8, 2
  s_add_u32 s14, s14, s10
  s_lshl_b32 s14, s14, 4
  s_lshl_b32 s15, s11, 3
  s_add_u32 s14, s14, s15
  s_lshl_b32 s14, s14, 11
  s_lshl_b32 s15, s8, 7
  s_add_u32 s15, s15, 8192
  s_mov_b32 s62, 4096
  s_mov_b32 s63, 6144
  s_lshl_b32 s60, s6, 3
  s_add_u32 s60, s60, s5
  s_mul_i32 s60, s60, 640
  s_lshl_b32 s61, s9, 3
  s_add_u32 s61, s61, s5
  s_mul_i32 s61, s61, 2432
  s_lshl_b32 s65, s8, 17
  s_add_u32 s61, s61, s65
  v_lshlrev_b32 v10, 7, v2
  s_lshl_b32 s65, s5, 12
  s_add_u32 s65, s65, 57344
  v_add_u32 v11, s65, v4
  s_lshl_b32 s65, s11, 14
  s_add_u32 s65, s65, 57344
  v_add_u32 v5, s65, v4
  v_lshrrev_b32 v6, 5, v2
  v_mul_u32_u24 v6, 224, v6
  v_bfe_u32 v7, v2, 2, 2
  v_add_u32 v6, v6, v7
  s_mul_i32 s65, s11, 112
  v_add_u32 v6, s65, v6
  v_lshlrev_b32 v6, 7, v6
  v_bfe_u32 v7, v2, 4, 1
  v_lshlrev_b32 v7, 5, v7
  v_and_b32 v12, 3, v2
  v_lshl_add_u32 v7, v12, 3, v7
  v_bfe_u32 v12, v2, 3, 1
  v_lshl_add_u32 v7, v12, 6, v7
  v_add_u32 v6, v6, v7
  v_xor_b32 v7, 64, v6
  s_cmp_eq_u32 s5, 0
  s_cbranch_scc1 Lpp_34
  s_branch Lps_33
Lpp_34:
  s_movk_i32 s64, 4000
  buffer_load_dword v240, v8, s[68:71], s15 offen sc1
  buffer_load_dword v241, v9, s[68:71], s62 offen sc1
  buffer_load_dword v242, v9, s[68:71], s63 offen sc1
  s_sleep 6
Lpo_32:
  buffer_load_dword v244, v8, s[68:71], s15 offen sc1
  buffer_load_dword v245, v9, s[68:71], s62 offen sc1
  buffer_load_dword v246, v9, s[68:71], s63 offen sc1
  s_waitcnt vmcnt(3)
  v_and_b32 v240, v240, v241
  v_and_b32 v240, v240, v242
  v_cmp_ne_u32 vcc, 1, v240
  s_sub_u32 s64, s64, 1
  s_cbranch_scc1 Lps_33
  s_cbranch_vccz Lps_33
  buffer_load_dword v240, v8, s[68:71], s15 offen sc1
  buffer_load_dword v241, v9, s[68:71], s62 offen sc1
  buffer_load_dword v242, v9, s[68:71], s63 offen sc1
  s_waitcnt vmcnt(3)
  v_and_b32 v244, v244, v245
  v_and_b32 v244, v244, v246
  v_cmp_ne_u32 vcc, 1, v244
  s_sub_u32 s64, s64, 1
  s_cbranch_scc1 Lps_33
  s_cbranch_vccz Lps_33
  s_branch Lpo_32
Lps_33:
  s_barrier
  s_mov_b32 s62, 0x358637bd
  buffer_load_dwordx4 v[64:67], v3, s[44:47], s12 offen offset:0
  buffer_load_dwordx4 v[68:71], v3, s[44:47], s12 offen offset:1024
  buffer_load_dwordx4 v[72:75], v3, s[44:47], s12 offen offset:2048
  buffer_load_dwordx4 v[76:79], v3, s[44:47], s12 offen offset:3072
  buffer_load_dwordx4 v[80:83], v3, s[44:47], s13 offen offset:0
  buffer_load_dwordx4 v[84:87], v3, s[44:47], s13 offen offset:1024
  buffer_load_dwordx4 v[88:91], v3, s[44:47], s13 offen offset:2048
  buffer_load_dwordx4 v[92:95], v3, s[44:47], s13 offen offset:3072
  s_waitcnt vmcnt(0)
  v_cvt_pk_bf16_f32 v32, v64, v65
  v_cvt_pk_bf16_f32 v33, v66, v67
  v_cvt_pk_bf16_f32 v34, v68, v69
  v_cvt_pk_bf16_f32 v35, v70, v71
  v_cvt_pk_bf16_f32 v36, v72, v73
  v_cvt_pk_bf16_f32 v37, v74, v75
  v_cvt_pk_bf16_f32 v38, v76, v77
  v_cvt_pk_bf16_f32 v39, v78, v79
  v_cvt_pk_bf16_f32 v40, v80, v81
  v_cvt_pk_bf16_f32 v41, v82, v83
  v_cvt_pk_bf16_f32 v42, v84, v85
  v_cvt_pk_bf16_f32 v43, v86, v87
  v_cvt_pk_bf16_f32 v44, v88, v89
  v_cvt_pk_bf16_f32 v45, v90, v91
  v_cvt_pk_bf16_f32 v46, v92, v93
  v_cvt_pk_bf16_f32 v47, v94, v95
  s_mov_b32 exec_lo, 0
  v_mov_b32 v38, 0
  v_mov_b32 v39, 0
  v_mov_b32 v46, 0
  v_mov_b32 v47, 0
  s_mov_b64 exec, -1
  ds_write_b128 v11, v[32:35] offset:0
  ds_write_b128 v11, v[36:39] offset:1024
  ds_write_b128 v11, v[40:43] offset:2048
  ds_write_b128 v11, v[44:47] offset:3072
  buffer_load_dwordx4 v[96:99], v4, s[48:51], s14 offen offset:0
  buffer_load_dwordx4 v[100:103], v4, s[48:51], s14 offen offset:1024
  buffer_load_dwordx4 v[104:107], v4, s[48:51], s14 offen offset:2048
  buffer_load_dwordx4 v[108:111], v4, s[48:51], s14 offen offset:3072
  s_add_u32 s14, s14, 4096
  buffer_load_dwordx4 v[112:115], v4, s[48:51], s14 offen offset:0
  buffer_load_dwordx4 v[116:119], v4, s[48:51], s14 offen offset:1024
  s_waitcnt lgkmcnt(0)
  s_barrier
  buffer_load_dwordx4 v[120:123], v4, s[48:51], s14 offen offset:2048
  buffer_load_dwordx4 v[124:127], v4, s[48:51], s14 offen offset:3072
  s_add_u32 s14, s14, 4096
  ds_read_b128 v[160:163], v5 offset:0
  ds_read_b128 v[164:167], v5 offset:1024
  ds_read_b128 v[168:171], v5 offset:2048
  ds_read_b128 v[172:175], v5 offset:3072
  ds_read_b128 v[176:179], v5 offset:4096
  ds_read_b128 v[180:183], v5 offset:5120
  ds_read_b128 v[184:187], v5 offset:6144
  ds_read_b128 v[188:191], v5 offset:7168
  s_waitcnt vmcnt(6) lgkmcnt(6)
  v_mfma_f32_32x32x16_bf16 v[32:47], v[160:163], v[96:99], 0
  v_mfma_f32_32x32x16_bf16 v[32:47], v[164:167], v[100:103], v[32:47]
  ds_read_b128 v[192:195], v5 offset:8192
  ds_read_b128 v[196:199], v5 offset:9216
  ds_read_b128 v[200:203], v5 offset:10240
  ds_read_b128 v[204:207], v5 offset:11264
  ds_read_b128 v[208:211], v5 offset:12288
  ds_read_b128 v[212:215], v5 offset:13312
  ds_read_b128 v[216:219], v5 offset:14336
  ds_read_b128 v[220:223], v5 offset:15360
  s_waitcnt lgkmcnt(7)
  ds_read_b64_tr_b16 v[8:9], v6 offset:0
  ds_read_b64_tr_b16 v[10:11], v6 offset:512
  ds_read_b64_tr_b16 v[12:13], v7 offset:0
  ds_read_b64_tr_b16 v[14:15], v7 offset:512
  ds_read_b64_tr_b16 v[16:17], v6 offset:1024
  ds_read_b64_tr_b16 v[18:19], v6 offset:1536
  ds_read_b64_tr_b16 v[20:21], v7 offset:1024
  ds_read_b64_tr_b16 v[22:23], v7 offset:1536
  buffer_load_dwordx4 v[128:131], v4, s[48:51], s14 offen offset:0
  buffer_load_dwordx4 v[132:135], v4, s[48:51], s14 offen offset:1024
  s_waitcnt vmcnt(6)
  v_mfma_f32_32x32x16_bf16 v[48:63], v[168:171], v[104:107], 0
  v_mfma_f32_32x32x16_bf16 v[48:63], v[172:175], v[108:111], v[48:63]
  v_add_f32 v64, s62, v46
  v_rcp_f32 v64, v64
  s_nop 0
  v_mul_f32 v32, v32, v64
  v_mul_f32 v33, v33, v64
  v_mul_f32 v34, v34, v64
  v_mul_f32 v35, v35, v64
  v_mul_f32 v36, v36, v64
  v_mul_f32 v37, v37, v64
  v_mul_f32 v38, v38, v64
  v_mul_f32 v39, v39, v64
  v_mul_f32 v40, v40, v64
  v_mul_f32 v41, v41, v64
  v_mul_f32 v42, v42, v64
  v_mul_f32 v43, v43, v64
  v_mul_f32 v44, v44, v64
  v_mul_f32 v45, v45, v64
  v_cvt_pk_bf16_f32 v88, v32, v33
  v_cvt_pk_bf16_f32 v89, v34, v35
  v_cvt_pk_bf16_f32 v90, v36, v37
  v_cvt_pk_bf16_f32 v91, v38, v39
  v_cvt_pk_bf16_f32 v92, v40, v41
  v_cvt_pk_bf16_f32 v93, v42, v43
  v_cvt_pk_bf16_f32 v94, v44, v45
  buffer_load_dwordx4 v[136:139], v4, s[48:51], s14 offen offset:2048
  buffer_load_dwordx4 v[140:143], v4, s[48:51], s14 offen offset:3072
  s_add_u32 s14, s14, 4096
  s_waitcnt vmcnt(6)
  v_mfma_f32_32x32x16_bf16 v[32:47], v[176:179], v[112:115], 0
  v_mfma_f32_32x32x16_bf16 v[32:47], v[180:183], v[116:119], v[32:47]
  v_add_f32 v64, s62, v62
  v_rcp_f32 v64, v64
  s_nop 0
  v_mul_f32 v48, v48, v64
  v_mul_f32 v49, v49, v64
  v_mul_f32 v50, v50, v64
  v_mul_f32 v51, v51, v64
  v_mul_f32 v52, v52, v64
  v_mul_f32 v53, v53, v64
  v_mul_f32 v54, v54, v64
  v_mul_f32 v55, v55, v64
  v_mul_f32 v56, v56, v64
  s_waitcnt lgkmcnt(4)
  v_mfma_f32_32x32x16_bf16 v[224:239], v[8:11], v[88:91], 0
  v_mfma_f32_32x32x16_bf16 v[240:255], v[12:15], v[88:91], 0
  ds_read_b64_tr_b16 v[24:25], v6 offset:2048
  ds_read_b64_tr_b16 v[26:27], v6 offset:2560
  ds_read_b64_tr_b16 v[28:29], v7 offset:2048
  ds_read_b64_tr_b16 v[30:31], v7 offset:2560
  v_mul_f32 v57, v57, v64
  v_mul_f32 v58, v58, v64
  v_mul_f32 v59, v59, v64
  v_mul_f32 v60, v60, v64
  v_mul_f32 v61, v61, v64
  v_cvt_pk_bf16_f32 v95, v48, v49
  v_cvt_pk_bf16_f32 v96, v50, v51
  v_cvt_pk_bf16_f32 v97, v52, v53
  v_cvt_pk_bf16_f32 v98, v54, v55
  v_cvt_pk_bf16_f32 v99, v56, v57
  v_cvt_pk_bf16_f32 v100, v58, v59
  v_cvt_pk_bf16_f32 v101, v60, v61
  buffer_load_dwordx4 v[144:147], v4, s[48:51], s14 offen offset:0
  buffer_load_dwordx4 v[148:151], v4, s[48:51], s14 offen offset:1024
  s_waitcnt vmcnt(6)
  v_mfma_f32_32x32x16_bf16 v[48:63], v[184:187], v[120:123], 0
  v_mfma_f32_32x32x16_bf16 v[48:63], v[188:191], v[124:127], v[48:63]
  v_add_f32 v64, s62, v46
  v_rcp_f32 v64, v64
  s_nop 0
  v_mul_f32 v32, v32, v64
  v_mul_f32 v33, v33, v64
  v_mul_f32 v34, v34, v64
  v_mul_f32 v35, v35, v64
  v_mul_f32 v36, v36, v64
  s_waitcnt lgkmcnt(4)
  v_mfma_f32_32x32x16_bf16 v[224:239], v[16:19], v[92:95], v[224:239]
  v_mfma_f32_32x32x16_bf16 v[240:255], v[20:23], v[92:95], v[240:255]
  ds_read_b64_tr_b16 v[8:9], v6 offset:3072
  ds_read_b64_tr_b16 v[10:11], v6 offset:3584
  ds_read_b64_tr_b16 v[12:13], v7 offset:3072
  ds_read_b64_tr_b16 v[14:15], v7 offset:3584
  v_mul_f32 v37, v37, v64
  v_mul_f32 v38, v38, v64
  v_mul_f32 v39, v39, v64
  v_mul_f32 v40, v40, v64
  v_mul_f32 v41, v41, v64
  v_mul_f32 v42, v42, v64
  v_mul_f32 v43, v43, v64
  v_mul_f32 v44, v44, v64
  s_waitcnt lgkmcnt(4)
  v_mfma_f32_32x32x16_bf16 v[224:239], v[24:27], v[96:99], v[224:239]
  v_mfma_f32_32x32x16_bf16 v[240:255], v[28:31], v[96:99], v[240:255]
  ds_read_b64_tr_b16 v[16:17], v6 offset:4096
  ds_read_b64_tr_b16 v[18:19], v6 offset:4608
  ds_read_b64_tr_b16 v[20:21], v7 offset:4096
  ds_read_b64_tr_b16 v[22:23], v7 offset:4608
  v_mul_f32 v45, v45, v64
  v_cvt_pk_bf16_f32 v102, v32, v33
  v_cvt_pk_bf16_f32 v103, v34, v35
  v_cvt_pk_bf16_f32 v104, v36, v37
  v_cvt_pk_bf16_f32 v105, v38, v39
  v_cvt_pk_bf16_f32 v106, v40, v41
  v_cvt_pk_bf16_f32 v107, v42, v43
  v_cvt_pk_bf16_f32 v108, v44, v45
  buffer_load_dwordx4 v[152:155], v4, s[48:51], s14 offen offset:2048
  buffer_load_dwordx4 v[156:159], v4, s[48:51], s14 offen offset:3072
  s_waitcnt vmcnt(6)
  v_mfma_f32_32x32x16_bf16 v[32:47], v[192:195], v[128:131], 0
  v_mfma_f32_32x32x16_bf16 v[32:47], v[196:199], v[132:135], v[32:47]
  v_add_f32 v64, s62, v62
  v_rcp_f32 v64, v64
  s_nop 0
  v_mul_f32 v48, v48, v64
  v_mul_f32 v49, v49, v64
  v_mul_f32 v50, v50, v64
  v_mul_f32 v51, v51, v64
  v_mul_f32 v52, v52, v64
  s_waitcnt lgkmcnt(4)
  v_mfma_f32_32x32x16_bf16 v[224:239], v[8:11], v[100:103], v[224:239]
  v_mfma_f32_32x32x16_bf16 v[240:255], v[12:15], v[100:103], v[240:255]
  ds_read_b64_tr_b16 v[24:25], v6 offset:5120
  ds_read_b64_tr_b16 v[26:27], v6 offset:5632
  ds_read_b64_tr_b16 v[28:29], v7 offset:5120
  ds_read_b64_tr_b16 v[30:31], v7 offset:5632
  v_mul_f32 v53, v53, v64
  v_mul_f32 v54, v54, v64
  v_mul_f32 v55, v55, v64
  v_mul_f32 v56, v56, v64
  v_mul_f32 v57, v57, v64
  v_mul_f32 v58, v58, v64
  v_mul_f32 v59, v59, v64
  v_mul_f32 v60, v60, v64
  s_waitcnt lgkmcnt(4)
  v_mfma_f32_32x32x16_bf16 v[224:239], v[16:19], v[104:107], v[224:239]
  v_mfma_f32_32x32x16_bf16 v[240:255], v[20:23], v[104:107], v[240:255]
  ds_read_b64_tr_b16 v[8:9], v6 offset:6144
  ds_read_b64_tr_b16 v[10:11], v6 offset:6656
  ds_read_b64_tr_b16 v[12:13], v7 offset:6144
  ds_read_b64_tr_b16 v[14:15], v7 offset:6656
  v_mul_f32 v61, v61, v64
  v_cvt_pk_bf16_f32 v109, v48, v49
  v_cvt_pk_bf16_f32 v110, v50, v51
  v_cvt_pk_bf16_f32 v111, v52, v53
  v_cvt_pk_bf16_f32 v112, v54, v55
  v_cvt_pk_bf16_f32 v113, v56, v57
  v_cvt_pk_bf16_f32 v114, v58, v59
  v_cvt_pk_bf16_f32 v115, v60, v61
  s_waitcnt vmcnt(4)
  v_mfma_f32_32x32x16_bf16 v[48:63], v[200:203], v[136:139], 0
  v_mfma_f32_32x32x16_bf16 v[48:63], v[204:207], v[140:143], v[48:63]
  v_add_f32 v64, s62, v46
  v_rcp_f32 v64, v64
  s_nop 0
  v_mul_f32 v32, v32, v64
  v_mul_f32 v33, v33, v64
  v_mul_f32 v34, v34, v64
  v_mul_f32 v35, v35, v64
  v_mul_f32 v36, v36, v64
  s_waitcnt lgkmcnt(4)
  v_mfma_f32_32x32x16_bf16 v[224:239], v[24:27], v[108:111], v[224:239]
  v_mfma_f32_32x32x16_bf16 v[240:255], v[28:31], v[108:111], v[240:255]
  ds_read_b64_tr_b16 v[16:17], v6 offset:7168
  ds_read_b64_tr_b16 v[18:19], v6 offset:7680
  ds_read_b64_tr_b16 v[20:21], v7 offset:7168
  ds_read_b64_tr_b16 v[22:23], v7 offset:7680
  v_mul_f32 v37, v37, v64
  v_mul_f32 v38, v38, v64
  v_mul_f32 v39, v39, v64
  v_mul_f32 v40, v40, v64
  v_mul_f32 v41, v41, v64
  v_mul_f32 v42, v42, v64
  v_mul_f32 v43, v43, v64
  v_mul_f32 v44, v44, v64
  s_waitcnt lgkmcnt(4)
  v_mfma_f32_32x32x16_bf16 v[224:239], v[8:11], v[112:115], v[224:239]
  v_mfma_f32_32x32x16_bf16 v[240:255], v[12:15], v[112:115], v[240:255]
  ds_read_b64_tr_b16 v[24:25], v6 offset:8192
  ds_read_b64_tr_b16 v[26:27], v6 offset:8704
  ds_read_b64_tr_b16 v[28:29], v7 offset:8192
  ds_read_b64_tr_b16 v[30:31], v7 offset:8704
  v_mul_f32 v45, v45, v64
  v_cvt_pk_bf16_f32 v116, v32, v33
  v_cvt_pk_bf16_f32 v117, v34, v35
  v_cvt_pk_bf16_f32 v118, v36, v37
  v_cvt_pk_bf16_f32 v119, v38, v39
  v_cvt_pk_bf16_f32 v120, v40, v41
  v_cvt_pk_bf16_f32 v121, v42, v43
  v_cvt_pk_bf16_f32 v122, v44, v45
  s_waitcnt vmcnt(2)
  v_mfma_f32_32x32x16_bf16 v[32:47], v[208:211], v[144:147], 0
  v_mfma_f32_32x32x16_bf16 v[32:47], v[212:215], v[148:151], v[32:47]
  v_add_f32 v64, s62, v62
  v_rcp_f32 v64, v64
  s_nop 0
  v_mul_f32 v48, v48, v64
  v_mul_f32 v49, v49, v64
  v_mul_f32 v50, v50, v64
  v_mul_f32 v51, v51, v64
  v_mul_f32 v52, v52, v64
  v_mul_f32 v53, v53, v64
  v_mul_f32 v54, v54, v64
  v_mul_f32 v55, v55, v64
  v_mul_f32 v56, v56, v64
  s_waitcnt lgkmcnt(4)
  v_mfma_f32_32x32x16_bf16 v[224:239], v[16:19], v[116:119], v[224:239]
  v_mfma_f32_32x32x16_bf16 v[240:255], v[20:23], v[116:119], v[240:255]
  ds_read_b64_tr_b16 v[8:9], v6 offset:9216
  ds_read_b64_tr_b16 v[10:11], v6 offset:9728
  ds_read_b64_tr_b16 v[12:13], v7 offset:9216
  ds_read_b64_tr_b16 v[14:15], v7 offset:9728
  v_mul_f32 v57, v57, v64
  v_mul_f32 v58, v58, v64
  v_mul_f32 v59, v59, v64
  v_mul_f32 v60, v60, v64
  v_mul_f32 v61, v61, v64
  v_cvt_pk_bf16_f32 v123, v48, v49
  v_cvt_pk_bf16_f32 v124, v50, v51
  v_cvt_pk_bf16_f32 v125, v52, v53
  v_cvt_pk_bf16_f32 v126, v54, v55
  v_cvt_pk_bf16_f32 v127, v56, v57
  v_cvt_pk_bf16_f32 v128, v58, v59
  v_cvt_pk_bf16_f32 v129, v60, v61
  s_waitcnt vmcnt(0)
  v_mfma_f32_32x32x16_bf16 v[48:63], v[216:219], v[152:155], 0
  v_mfma_f32_32x32x16_bf16 v[48:63], v[220:223], v[156:159], v[48:63]
  v_add_f32 v64, s62, v46
  v_rcp_f32 v64, v64
  s_nop 0
  v_mul_f32 v32, v32, v64
  v_mul_f32 v33, v33, v64
  v_mul_f32 v34, v34, v64
  v_mul_f32 v35, v35, v64
  v_mul_f32 v36, v36, v64
  s_waitcnt lgkmcnt(4)
  v_mfma_f32_32x32x16_bf16 v[224:239], v[24:27], v[120:123], v[224:239]
  v_mfma_f32_32x32x16_bf16 v[240:255], v[28:31], v[120:123], v[240:255]
  ds_read_b64_tr_b16 v[16:17], v6 offset:10240
  ds_read_b64_tr_b16 v[18:19], v6 offset:10752
  ds_read_b64_tr_b16 v[20:21], v7 offset:10240
  ds_read_b64_tr_b16 v[22:23], v7 offset:10752
  v_mul_f32 v37, v37, v64
  v_mul_f32 v38, v38, v64
  v_mul_f32 v39, v39, v64
  v_mul_f32 v40, v40, v64
  v_mul_f32 v41, v41, v64
  v_mul_f32 v42, v42, v64
  v_mul_f32 v43, v43, v64
  v_mul_f32 v44, v44, v64
  s_waitcnt lgkmcnt(4)
  v_mfma_f32_32x32x16_bf16 v[224:239], v[8:11], v[124:127], v[224:239]
  v_mfma_f32_32x32x16_bf16 v[240:255], v[12:15], v[124:127], v[240:255]
  ds_read_b64_tr_b16 v[24:25], v6 offset:11264
  ds_read_b64_tr_b16 v[26:27], v6 offset:11776
  ds_read_b64_tr_b16 v[28:29], v7 offset:11264
  ds_read_b64_tr_b16 v[30:31], v7 offset:11776
  v_mul_f32 v45, v45, v64
  v_cvt_pk_bf16_f32 v130, v32, v33
  v_cvt_pk_bf16_f32 v131, v34, v35
  v_cvt_pk_bf16_f32 v132, v36, v37
  v_cvt_pk_bf16_f32 v133, v38, v39
  v_cvt_pk_bf16_f32 v134, v40, v41
  v_cvt_pk_bf16_f32 v135, v42, v43
  v_cvt_pk_bf16_f32 v136, v44, v45
  v_add_f32 v64, s62, v62
  v_rcp_f32 v64, v64
  s_nop 0
  v_mul_f32 v48, v48, v64
  v_mul_f32 v49, v49, v64
  v_mul_f32 v50, v50, v64
  v_mul_f32 v51, v51, v64
  v_mul_f32 v52, v52, v64
  s_waitcnt lgkmcnt(4)
  v_mfma_f32_32x32x16_bf16 v[224:239], v[16:19], v[128:131], v[224:239]
  v_mfma_f32_32x32x16_bf16 v[240:255], v[20:23], v[128:131], v[240:255]
  ds_read_b64_tr_b16 v[8:9], v6 offset:12288
  ds_read_b64_tr_b16 v[10:11], v6 offset:12800
  ds_read_b64_tr_b16 v[12:13], v7 offset:12288
  ds_read_b64_tr_b16 v[14:15], v7 offset:12800
  v_mul_f32 v53, v53, v64
  v_mul_f32 v54, v54, v64
  v_mul_f32 v55, v55, v64
  v_mul_f32 v56, v56, v64
  v_mul_f32 v57, v57, v64
  v_mul_f32 v58, v58, v64
  v_mul_f32 v59, v59, v64
  v_mul_f32 v60, v60, v64
  s_waitcnt lgkmcnt(4)
  v_mfma_f32_32x32x16_bf16 v[224:239], v[24:27], v[132:135], v[224:239]
  v_mfma_f32_32x32x16_bf16 v[240:255], v[28:31], v[132:135], v[240:255]
  ds_read_b64_tr_b16 v[16:17], v6 offset:13312
  ds_read_b64_tr_b16 v[18:19], v6 offset:13824
  ds_read_b64_tr_b16 v[20:21], v7 offset:13312
  ds_read_b64_tr_b16 v[22:23], v7 offset:13824
  v_mul_f32 v61, v61, v64
  v_cvt_pk_bf16_f32 v137, v48, v49
  v_cvt_pk_bf16_f32 v138, v50, v51
  v_cvt_pk_bf16_f32 v139, v52, v53
  v_cvt_pk_bf16_f32 v140, v54, v55
  v_cvt_pk_bf16_f32 v141, v56, v57
  v_cvt_pk_bf16_f32 v142, v58, v59
  v_cvt_pk_bf16_f32 v143, v60, v61
  s_nop 1
  s_waitcnt lgkmcnt(4)
  v_mfma_f32_32x32x16_bf16 v[224:239], v[8:11], v[136:139], v[224:239]
  v_mfma_f32_32x32x16_bf16 v[240:255], v[12:15], v[136:139], v[240:255]
  s_waitcnt lgkmcnt(0)
  v_mfma_f32_32x32x16_bf16 v[224:239], v[16:19], v[140:143], v[224:239]
  v_mfma_f32_32x32x16_bf16 v[240:255], v[20:23], v[140:143], v[240:255]
  s_lshl_b32 s12, s5, 12
  s_add_u32 s12, s12, 90112
  v_add_u32 v6, s12, v4
  s_xor_b32 s13, s5, 4
  s_lshl_b32 s13, s13, 12
  s_add_u32 s13, s13, 90112
  v_add_u32 v7, s13, v4
  v_and_b32 v8, 31, v2
  s_lshl_b32 s12, s10, 5
  v_add_u32 v8, s12, v8
  v_mul_u32_u24 v8, 144, v8
  v_lshrrev_b32 v9, 5, v2
  v_lshl_add_u32 v8, v9, 3, v8
  s_lshl_b32 s12, s11, 6
  s_add_u32 s12, s12, 122880
  v_add_u32 v8, s12, v8
  s_cmp_lg_u32 s11, 0
  s_cbranch_scc1 Leh_35
  ds_write_b128 v6, v[240:243] offset:0
  ds_write_b128 v6, v[244:247] offset:1024
  ds_write_b128 v6, v[248:251] offset:2048
  ds_write_b128 v6, v[252:255] offset:3072
  s_branch Lej_36
Leh_35:
  ds_write_b128 v6, v[224:227] offset:0
  ds_write_b128 v6, v[228:231] offset:1024
  ds_write_b128 v6, v[232:235] offset:2048
  ds_write_b128 v6, v[236:239] offset:3072
  v_mov_b32 v224, v240
  v_mov_b32 v225, v241
  v_mov_b32 v226, v242
  v_mov_b32 v227, v243
  v_mov_b32 v228, v244
  v_mov_b32 v229, v245
  v_mov_b32 v230, v246
  v_mov_b32 v231, v247
  v_mov_b32 v232, v248
  v_mov_b32 v233, v249
  v_mov_b32 v234, v250
  v_mov_b32 v235, v251
  v_mov_b32 v236, v252
  v_mov_b32 v237, v253
  v_mov_b32 v238, v254
  v_mov_b32 v239, v255
Lej_36:
  v_lshrrev_b32 v9, 3, v0
  v_and_b32 v10, 7, v0
  v_mul_u32_u24 v12, 144, v9
  v_lshl_add_u32 v12, v10, 4, v12
  v_add_u32 v12, 122880, v12
  v_mul_u32_u24 v11, 1792, v9
  v_lshl_add_u32 v11, v10, 4, v11
  s_mul_i32 s12, s8, 229376
  s_lshl_b32 s13, s9, 7
  s_add_u32 s12, s12, s13
  s_add_u32 s12, s12, 896
  s_add_u32 s13, s12, 114688
  s_waitcnt lgkmcnt(0)
  s_barrier
  ds_read_b128 v[64:67], v7 offset:0
  ds_read_b128 v[68:71], v7 offset:1024
  ds_read_b128 v[72:75], v7 offset:2048
  ds_read_b128 v[76:79], v7 offset:3072
  s_waitcnt lgkmcnt(3)
  v_add_f32 v64, v64, v224
  v_add_f32 v65, v65, v225
  v_add_f32 v66, v66, v226
  v_add_f32 v67, v67, v227
  v_cvt_pk_bf16_f32 v80, v64, v65
  v_cvt_pk_bf16_f32 v81, v66, v67
  ds_write_b64 v8, v[80:81] offset:0
  s_waitcnt lgkmcnt(3)
  v_add_f32 v68, v68, v228
  v_add_f32 v69, v69, v229
  v_add_f32 v70, v70, v230
  v_add_f32 v71, v71, v231
  v_cvt_pk_bf16_f32 v82, v68, v69
  v_cvt_pk_bf16_f32 v83, v70, v71
  ds_write_b64 v8, v[82:83] offset:16
  s_waitcnt lgkmcnt(3)
  v_add_f32 v72, v72, v232
  v_add_f32 v73, v73, v233
  v_add_f32 v74, v74, v234
  v_add_f32 v75, v75, v235
  v_cvt_pk_bf16_f32 v84, v72, v73
  v_cvt_pk_bf16_f32 v85, v74, v75
  ds_write_b64 v8, v[84:85] offset:32
  s_waitcnt lgkmcnt(3)
  v_add_f32 v76, v76, v236
  v_add_f32 v77, v77, v237
  v_add_f32 v78, v78, v238
  v_add_f32 v79, v79, v239
  v_cvt_pk_bf16_f32 v86, v76, v77
  v_cvt_pk_bf16_f32 v87, v78, v79
  ds_write_b64 v8, v[86:87] offset:48
  s_waitcnt lgkmcnt(0)
  s_barrier
  ds_read_b128 v[96:99], v12 offset:0
  ds_read_b128 v[100:103], v12 offset:9216
  s_waitcnt lgkmcnt(1)
  buffer_store_dwordx4 v[96:99], v11, s[56:59], s12 offen sc1
  s_waitcnt lgkmcnt(0)
  buffer_store_dwordx4 v[100:103], v11, s[56:59], s13 offen sc1
  s_endpgm
L_conv:
  s_lshl_b32 s6, s3, 6
  s_lshl_b32 s7, s4, 2
  s_add_u32 s6, s6, s7
  s_and_b32 s7, s5, 3
  s_lshr_b32 s8, s5, 2
  v_lshrrev_b32 v3, 4, v2
  v_sub_u32 v3, v2, v3
  v_and_b32 v3, 3, v3
  v_and_b32 v4, 60, v2
  v_add_lshl_u32 v3, v3, v4, 4
  s_lshl_b32 s9, s5, 10
  s_lshl_b32 s10, s6, 12
  s_add_u32 s9, s9, s10
  s_lshl_b32 s10, s5, 10
  s_add_u32 s10, s10, 2048
  v_lshlrev_b32 v4, 4, v2
  s_add_u32 s11, s6, s7
  s_mul_i32 s11, s11, 4224
  s_lshl_b32 s12, s7, 2
  s_add_u32 s12, s12, s8
  s_mul_i32 s12, s12, 4288
  s_add_u32 s12, s12, 18432
  v_mov_b32 v8, 0
  v_mov_b32 v9, 0
  v_mov_b32 v10, 0
  v_mov_b32 v11, 0
  s_add_u32 s44, s40, 0x600000
  s_addc_u32 s45, s41, 0
  s_mov_b32 s46, 0x1c0000
  s_mov_b32 s47, 0x20000
  s_add_u32 s48, s40, 0x210000
  s_addc_u32 s49, s41, 0
  s_mov_b32 s50, 0x1ce000
  s_mov_b32 s51, 0x20000
  s_mov_b32 s52, s36
  s_mov_b32 s53, s37
  s_mov_b32 s54, 0x380000
  s_mov_b32 s55, 0x20000
  s_add_u32 s68, s40, 0x800000
  s_addc_u32 s69, s41, 0
  s_mov_b32 s70, 0x8000
  s_mov_b32 s71, 0x20000
  v_lshlrev_b32 v5, 5, v2
  v_and_b32 v6, 96, v5
  s_lshl_b32 s13, s6, 5
  s_add_u32 s13, s13, 16384
  s_mov_b32 s14, 2048
  s_waitcnt lgkmcnt(0)
  s_cmp_eq_u32 s66, 0
  s_cbranch_scc1 Lnq_37
  s_cmp_lg_u32 s5, 0
  s_cbranch_scc1 Lq0_38
  buffer_load_dword v248, v5, s[68:71], 0 offen sc1
  buffer_load_dword v249, v5, s[68:71], s14 offen sc1
  buffer_load_dword v250, v6, s[68:71], s13 offen sc1
  s_waitcnt vmcnt(3)
  s_barrier
  s_waitcnt vmcnt(0)
  v_and_b32 v248, v248, v249
  v_and_b32 v248, v248, v250
  v_cmp_ne_u32 vcc, 1, v248
  s_nop 4
  s_cbranch_vccz L_cp_done
  s_branch Lnq_37
Lq0_38:
  s_waitcnt vmcnt(0)
  s_barrier
  s_cmp_lg_u32 s5, 1
  s_cbranch_scc1 Lnq_37
  v_mov_b32 v7, 1
  s_mov_b64 exec, 1
  buffer_store_dword v7, v5, s[68:71], s66 offen sc1
  s_mov_b64 exec, -1
  s_branch L_cp_done
Lnq_37:
  s_cmp_eq_u32 s5, 0
  s_cbranch_scc1 Lpp_41
  s_waitcnt vmcnt(0)
  s_branch Lps_40
Lpp_41:
  s_movk_i32 s64, 4000
  buffer_load_dword v240, v5, s[68:71], 0 offen sc1
  buffer_load_dword v241, v5, s[68:71], s14 offen sc1
  buffer_load_dword v242, v6, s[68:71], s13 offen sc1
  s_sleep 6
Lpo_39:
  buffer_load_dword v244, v5, s[68:71], 0 offen sc1
  buffer_load_dword v245, v5, s[68:71], s14 offen sc1
  buffer_load_dword v246, v6, s[68:71], s13 offen sc1
  s_waitcnt vmcnt(3)
  v_and_b32 v240, v240, v241
  v_and_b32 v240, v240, v242
  v_cmp_ne_u32 vcc, 1, v240
  s_sub_u32 s64, s64, 1
  s_cbranch_scc1 Lps_40
  s_cbranch_vccz Lps_40
  buffer_load_dword v240, v5, s[68:71], 0 offen sc1
  buffer_load_dword v241, v5, s[68:71], s14 offen sc1
  buffer_load_dword v242, v6, s[68:71], s13 offen sc1
  s_waitcnt vmcnt(3)
  v_and_b32 v244, v244, v245
  v_and_b32 v244, v244, v246
  v_cmp_ne_u32 vcc, 1, v244
  s_sub_u32 s64, s64, 1
  s_cbranch_scc1 Lps_40
  s_cbranch_vccz Lps_40
  s_branch Lpo_39
Lps_40:
L_cp_done:
  s_barrier
  s_cmp_lg_u32 s8, 0
  s_cbranch_scc1 Lch_42
  s_add_u32 m0, s10, 0
  s_nop 0
  buffer_load_dwordx4 v3, s[44:47], s9 offen lds
  s_add_u32 s13, s11, 3072
  s_add_u32 m0, s12, 3072
  s_nop 0
  buffer_load_dwordx4 v4, s[48:51], s13 offen lds
  s_add_u32 s13, s11, 3076
  s_add_u32 m0, s12, 11648
  s_nop 0
  buffer_load_dwordx4 v4, s[48:51], s13 offen lds
  s_add_u32 s13, s11, 2048
  s_add_u32 m0, s12, 2048
  s_nop 0
  buffer_load_dwordx4 v4, s[48:51], s13 offen lds
  s_add_u32 s13, s11, 2052
  s_add_u32 m0, s12, 10624
  s_nop 0
  buffer_load_dwordx4 v4, s[48:51], s13 offen lds
  s_add_u32 s9, s9, 8192
  s_add_u32 m0, s10, 8192
  s_nop 0
  buffer_load_dwordx4 v3, s[44:47], s9 offen lds
  s_add_u32 s13, s11, 1024
  s_add_u32 m0, s12, 1024
  s_nop 0
  buffer_load_dwordx4 v4, s[48:51], s13 offen lds
  s_add_u32 s13, s11, 1028
  s_add_u32 m0, s12, 9600
  s_nop 0
  buffer_load_dwordx4 v4, s[48:51], s13 offen lds
  s_add_u32 s13, s11, 0
  s_add_u32 m0, s12, 0
  s_nop 0
  buffer_load_dwordx4 v4, s[48:51], s13 offen lds
  s_add_u32 s13, s11, 4
  s_add_u32 m0, s12, 8576
  s_nop 0
  buffer_load_dwordx4 v4, s[48:51], s13 offen lds
  s_branch Lcj_43
Lch_42:
  s_add_u32 m0, s10, 0
  s_nop 0
  buffer_load_dwordx4 v3, s[44:47], s9 offen lds
  buffer_load_dwordx4 v[236:239], v4, s[48:51], s11 offen offset:3072
  buffer_load_dwordx2 v[240:241], v4, s[48:51], s11 offen offset:3088
  buffer_load_dwordx4 v[228:231], v4, s[48:51], s11 offen offset:2048
  buffer_load_dwordx2 v[232:233], v4, s[48:51], s11 offen offset:2064
  s_add_u32 s9, s9, 8192
  s_add_u32 m0, s10, 8192
  s_nop 0
  buffer_load_dwordx4 v3, s[44:47], s9 offen lds
  buffer_load_dwordx4 v[220:223], v4, s[48:51], s11 offen offset:1024
  buffer_load_dwordx2 v[224:225], v4, s[48:51], s11 offen offset:1040
  buffer_load_dwordx4 v[212:215], v4, s[48:51], s11 offen offset:0
  buffer_load_dwordx2 v[216:217], v4, s[48:51], s11 offen offset:16
Lcj_43:
  v_add_u32 v20, s12, v4
  s_lshl_b32 s13, s5, 10
  v_add_u32 v5, s13, v4
  s_cmp_lt_u32 s5, 2
  s_cselect_b32 s14, -1, 0
  s_cselect_b32 s15, -1, 0
  s_mov_b64 exec, s[14:15]
  ds_write_b128 v5, v[8:11]
  s_mov_b64 exec, 15
  v_add_u32 v5, s12, v4
  ds_write_b128 v5, v[8:11] offset:4096
  ds_write_b128 v5, v[8:11] offset:12672
  s_mov_b64 exec, -1
  v_and_b32 v5, 15, v2
  v_lshrrev_b32 v7, 4, v2
  v_lshl_add_u32 v6, v5, 1, v7
  s_lshl_b32 s13, s8, 4
  s_sub_u32 s13, 30, s13
  v_add_u32 v6, s13, v6
  v_subrev_u32 v8, 0, v6
  v_lshrrev_b32 v9, 2, v8
  v_add_u32 v9, s7, v9
  v_and_b32 v9, 3, v9
  v_lshlrev_b32 v9, 4, v9
  v_lshl_add_u32 v12, v8, 6, v9
  v_subrev_u32 v8, 4, v6
  v_lshrrev_b32 v9, 2, v8
  v_add_u32 v9, s7, v9
  v_and_b32 v9, 3, v9
  v_lshlrev_b32 v9, 4, v9
  v_lshl_add_u32 v13, v8, 6, v9
  v_subrev_u32 v8, 8, v6
  v_lshrrev_b32 v9, 2, v8
  v_add_u32 v9, s7, v9
  v_and_b32 v9, 3, v9
  v_lshlrev_b32 v9, 4, v9
  v_lshl_add_u32 v14, v8, 6, v9
  v_subrev_u32 v8, 12, v6
  v_lshrrev_b32 v9, 2, v8
  v_add_u32 v9, s7, v9
  v_and_b32 v9, 3, v9
  v_lshlrev_b32 v9, 4, v9
  v_lshl_add_u32 v15, v8, 6, v9
  v_sub_u32 v8, 3, v5
  v_and_b32 v8, 3, v8
  v_mul_u32_u24 v16, 4288, v8
  v_add_u32 v8, v8, v5
  v_lshlrev_b32 v9, 3, v7
  v_sub_u32 v9, v9, v8
  v_lshl_add_u32 v16, v9, 1, v16
  s_mul_i32 s13, s7, 17152
  s_lshl_b32 s14, s8, 8
  s_sub_u32 s13, s13, s14
  s_add_u32 s13, s13, 18718
  v_add_u32 v16, s13, v16
  s_lshl_b32 s13, s5, 12
  s_add_u32 s13, s13, 87040
  v_add_u32 v17, s13, v4
  v_lshlrev_b32 v18, 3, v0
  v_add_u32 v18, 87040, v18
  v_lshrrev_b32 v8, 5, v0
  v_lshlrev_b32 v8, 6, v8
  v_and_b32 v9, 1, v0
  v_lshl_add_u32 v8, v9, 5, v8
  v_bfe_u32 v9, v0, 1, 4
  v_add_u32 v8, v8, v9
  v_mul_u32_u24 v19, 1792, v8
  s_lshl_b32 s60, s6, 1
  s_add_u32 s61, s60, 28672
  s_waitcnt vmcnt(5)
  s_cmp_eq_u32 s8, 0
  s_cbranch_scc1 Lnb1_44
  v_alignbyte_b32 v244, v237, v236, 2
  v_alignbyte_b32 v245, v238, v237, 2
  v_alignbyte_b32 v246, v239, v238, 2
  v_alignbyte_b32 v247, v240, v239, 2
  v_alignbyte_b32 v248, v241, v240, 2
  v_mov_b32 v252, v245
  v_mov_b32 v253, v246
  v_mov_b32 v254, v247
  v_mov_b32 v255, v248
  ds_write_b128 v20, v[244:247] offset:3072
  ds_write_b128 v20, v[252:255] offset:11648
  v_alignbyte_b32 v244, v229, v228, 2
  v_alignbyte_b32 v245, v230, v229, 2
  v_alignbyte_b32 v246, v231, v230, 2
  v_alignbyte_b32 v247, v232, v231, 2
  v_alignbyte_b32 v248, v233, v232, 2
  v_mov_b32 v252, v245
  v_mov_b32 v253, v246
  v_mov_b32 v254, v247
  v_mov_b32 v255, v248
  ds_write_b128 v20, v[244:247] offset:2048
  ds_write_b128 v20, v[252:255] offset:10624
Lnb1_44:
  s_waitcnt lgkmcnt(0)
  s_barrier
  ds_read_b128 v[64:67], v12 offset:0
  ds_read_b64 v[80:81], v16 offset:3776
  ds_read_b64 v[82:83], v16 offset:3784
  ds_read_b128 v[68:71], v12 offset:2048
  ds_read_b64 v[84:85], v16 offset:3264
  ds_read_b64 v[86:87], v16 offset:3272
  ds_read_b128 v[72:75], v12 offset:4096
  ds_read_b64 v[88:89], v16 offset:2752
  ds_read_b64 v[90:91], v16 offset:2760
  ds_read_b128 v[76:79], v12 offset:6144
  ds_read_b64 v[92:93], v16 offset:2240
  ds_read_b64 v[94:95], v16 offset:2248
  ds_read_b128 v[96:99], v13 offset:0
  ds_read_b64 v[112:113], v16 offset:3712
  ds_read_b64 v[114:115], v16 offset:3720
  s_waitcnt lgkmcnt(3)
  v_mfma_f32_16x16x32_bf16 v[32:35], v[64:67], v[80:83], 0
  ds_read_b128 v[100:103], v13 offset:2048
  v_mfma_f32_16x16x32_bf16 v[36:39], v[68:71], v[80:83], 0
  ds_read_b64 v[116:117], v16 offset:3200
  v_mfma_f32_16x16x32_bf16 v[40:43], v[72:75], v[80:83], 0
  ds_read_b64 v[118:119], v16 offset:3208
  v_mfma_f32_16x16x32_bf16 v[44:47], v[76:79], v[80:83], 0
  ds_read_b128 v[104:107], v13 offset:4096
  v_mfma_f32_16x16x32_bf16 v[36:39], v[64:67], v[84:87], v[36:39]
  ds_read_b64 v[120:121], v16 offset:2688
  v_mfma_f32_16x16x32_bf16 v[40:43], v[68:71], v[84:87], v[40:43]
  ds_read_b64 v[122:123], v16 offset:2696
  v_mfma_f32_16x16x32_bf16 v[44:47], v[72:75], v[84:87], v[44:47]
  ds_read_b128 v[108:111], v13 offset:6144
  v_mfma_f32_16x16x32_bf16 v[40:43], v[64:67], v[88:91], v[40:43]
  ds_read_b64 v[124:125], v16 offset:2176
  v_mfma_f32_16x16x32_bf16 v[44:47], v[68:71], v[88:91], v[44:47]
  ds_read_b64 v[126:127], v16 offset:2184
  v_mfma_f32_16x16x32_bf16 v[44:47], v[64:67], v[92:95], v[44:47]
  ds_read_b128 v[128:131], v14 offset:0
  ds_read_b64 v[144:145], v16 offset:3648
  ds_read_b64 v[146:147], v16 offset:3656
  s_waitcnt lgkmcnt(3)
  v_mfma_f32_16x16x32_bf16 v[32:35], v[96:99], v[112:115], v[32:35]
  ds_read_b128 v[132:135], v14 offset:2048
  v_mfma_f32_16x16x32_bf16 v[36:39], v[100:103], v[112:115], v[36:39]
  ds_read_b64 v[148:149], v16 offset:3136
  v_mfma_f32_16x16x32_bf16 v[40:43], v[104:107], v[112:115], v[40:43]
  ds_read_b64 v[150:151], v16 offset:3144
  v_mfma_f32_16x16x32_bf16 v[44:47], v[108:111], v[112:115], v[44:47]
  ds_read_b128 v[136:139], v14 offset:4096
  v_mfma_f32_16x16x32_bf16 v[36:39], v[96:99], v[116:119], v[36:39]
  ds_read_b64 v[152:153], v16 offset:2624
  v_mfma_f32_16x16x32_bf16 v[40:43], v[100:103], v[116:119], v[40:43]
  ds_read_b64 v[154:155], v16 offset:2632
  v_mfma_f32_16x16x32_bf16 v[44:47], v[104:107], v[116:119], v[44:47]
  ds_read_b128 v[140:143], v14 offset:6144
  v_mfma_f32_16x16x32_bf16 v[40:43], v[96:99], v[120:123], v[40:43]
  ds_read_b64 v[156:157], v16 offset:2112
  v_mfma_f32_16x16x32_bf16 v[44:47], v[100:103], v[120:123], v[44:47]
  ds_read_b64 v[158:159], v16 offset:2120
  v_mfma_f32_16x16x32_bf16 v[44:47], v[96:99], v[124:127], v[44:47]
  ds_read_b128 v[160:163], v15 offset:0
  ds_read_b64 v[176:177], v16 offset:3584
  ds_read_b64 v[178:179], v16 offset:3592
  s_waitcnt lgkmcnt(3)
  v_mfma_f32_16x16x32_bf16 v[32:35], v[128:131], v[144:147], v[32:35]
  ds_read_b128 v[164:167], v15 offset:2048
  v_mfma_f32_16x16x32_bf16 v[36:39], v[132:135], v[144:147], v[36:39]
  ds_read_b64 v[180:181], v16 offset:3072
  v_mfma_f32_16x16x32_bf16 v[40:43], v[136:139], v[144:147], v[40:43]
  ds_read_b64 v[182:183], v16 offset:3080
  v_mfma_f32_16x16x32_bf16 v[44:47], v[140:143], v[144:147], v[44:47]
  ds_read_b128 v[168:171], v15 offset:4096
  v_mfma_f32_16x16x32_bf16 v[36:39], v[128:131], v[148:151], v[36:39]
  ds_read_b64 v[184:185], v16 offset:2560
  v_mfma_f32_16x16x32_bf16 v[40:43], v[132:135], v[148:151], v[40:43]
  ds_read_b64 v[186:187], v16 offset:2568
  v_mfma_f32_16x16x32_bf16 v[44:47], v[136:139], v[148:151], v[44:47]
  ds_read_b128 v[172:175], v15 offset:6144
  v_mfma_f32_16x16x32_bf16 v[40:43], v[128:131], v[152:155], v[40:43]
  ds_read_b64 v[188:189], v16 offset:2048
  v_mfma_f32_16x16x32_bf16 v[44:47], v[132:135], v[152:155], v[44:47]
  ds_read_b64 v[190:191], v16 offset:2056
  v_mfma_f32_16x16x32_bf16 v[44:47], v[128:131], v[156:159], v[44:47]
  s_waitcnt lgkmcnt(0)
  v_mfma_f32_16x16x32_bf16 v[32:35], v[160:163], v[176:179], v[32:35]
  v_mfma_f32_16x16x32_bf16 v[36:39], v[164:167], v[176:179], v[36:39]
  v_mfma_f32_16x16x32_bf16 v[40:43], v[168:171], v[176:179], v[40:43]
  v_mfma_f32_16x16x32_bf16 v[44:47], v[172:175], v[176:179], v[44:47]
  v_mfma_f32_16x16x32_bf16 v[36:39], v[160:163], v[180:183], v[36:39]
  v_mfma_f32_16x16x32_bf16 v[40:43], v[164:167], v[180:183], v[40:43]
  v_mfma_f32_16x16x32_bf16 v[44:47], v[168:171], v[180:183], v[44:47]
  v_mfma_f32_16x16x32_bf16 v[40:43], v[160:163], v[184:187], v[40:43]
  v_mfma_f32_16x16x32_bf16 v[44:47], v[164:167], v[184:187], v[44:47]
  v_mfma_f32_16x16x32_bf16 v[44:47], v[160:163], v[188:191], v[44:47]
  s_waitcnt vmcnt(0)
  s_cmp_eq_u32 s8, 0
  s_cbranch_scc1 Lnb2_45
  v_alignbyte_b32 v244, v221, v220, 2
  v_alignbyte_b32 v245, v222, v221, 2
  v_alignbyte_b32 v246, v223, v222, 2
  v_alignbyte_b32 v247, v224, v223, 2
  v_alignbyte_b32 v248, v225, v224, 2
  v_mov_b32 v252, v245
  v_mov_b32 v253, v246
  v_mov_b32 v254, v247
  v_mov_b32 v255, v248
  ds_write_b128 v20, v[244:247] offset:1024
  ds_write_b128 v20, v[252:255] offset:9600
  v_alignbyte_b32 v244, v213, v212, 2
  v_alignbyte_b32 v245, v214, v213, 2
  v_alignbyte_b32 v246, v215, v214, 2
  v_alignbyte_b32 v247, v216, v215, 2
  v_alignbyte_b32 v248, v217, v216, 2
  v_mov_b32 v252, v245
  v_mov_b32 v253, v246
  v_mov_b32 v254, v247
  v_mov_b32 v255, v248
  ds_write_b128 v20, v[244:247] offset:0
  ds_write_b128 v20, v[252:255] offset:8576
Lnb2_45:
  s_nop 4
  ds_write_b128 v17, v[32:35] offset:0
  ds_write_b128 v17, v[36:39] offset:1024
  ds_write_b128 v17, v[40:43] offset:2048
  ds_write_b128 v17, v[44:47] offset:3072
  s_waitcnt lgkmcnt(0)
  s_barrier
  ds_read_b128 v[192:195], v12 offset:8192
  ds_read_b64 v[208:209], v16 offset:1728
  ds_read_b64 v[210:211], v16 offset:1736
  ds_read_b128 v[196:199], v12 offset:10240
  ds_read_b64 v[212:213], v16 offset:1216
  ds_read_b64 v[214:215], v16 offset:1224
  ds_read_b128 v[200:203], v12 offset:12288
  ds_read_b64 v[216:217], v16 offset:704
  ds_read_b64 v[218:219], v16 offset:712
  ds_read_b128 v[204:207], v12 offset:14336
  ds_read_b64 v[220:221], v16 offset:192
  ds_read_b64 v[222:223], v16 offset:200
  v_mfma_f32_16x16x32_bf16 v[48:51], v[76:79], v[84:87], 0
  v_mfma_f32_16x16x32_bf16 v[52:55], v[76:79], v[88:91], 0
  v_mfma_f32_16x16x32_bf16 v[48:51], v[72:75], v[88:91], v[48:51]
  v_mfma_f32_16x16x32_bf16 v[52:55], v[72:75], v[92:95], v[52:55]
  v_mfma_f32_16x16x32_bf16 v[48:51], v[68:71], v[92:95], v[48:51]
  v_mfma_f32_16x16x32_bf16 v[56:59], v[76:79], v[92:95], 0
  s_waitcnt lgkmcnt(0)
  v_mfma_f32_16x16x32_bf16 v[48:51], v[192:195], v[80:83], v[48:51]
  ds_read_b64 v[32:33], v18 offset:0
  v_mfma_f32_16x16x32_bf16 v[52:55], v[192:195], v[84:87], v[52:55]
  ds_read_b64 v[34:35], v18 offset:4096
  v_mfma_f32_16x16x32_bf16 v[56:59], v[192:195], v[88:91], v[56:59]
  ds_read_b64 v[36:37], v18 offset:8192
  v_mfma_f32_16x16x32_bf16 v[60:63], v[192:195], v[92:95], 0
  ds_read_b64 v[38:39], v18 offset:12288
  v_mfma_f32_16x16x32_bf16 v[48:51], v[64:67], v[208:211], v[48:51]
  ds_read_b64 v[40:41], v18 offset:16384
  v_mfma_f32_16x16x32_bf16 v[52:55], v[68:71], v[208:211], v[52:55]
  ds_read_b64 v[42:43], v18 offset:20480
  v_mfma_f32_16x16x32_bf16 v[56:59], v[72:75], v[208:211], v[56:59]
  ds_read_b64 v[44:45], v18 offset:24576
  v_mfma_f32_16x16x32_bf16 v[60:63], v[76:79], v[208:211], v[60:63]
  ds_read_b64 v[46:47], v18 offset:28672
  v_mfma_f32_16x16x32_bf16 v[52:55], v[196:199], v[80:83], v[52:55]
  ds_read_b128 v[224:227], v13 offset:8192
  v_mfma_f32_16x16x32_bf16 v[56:59], v[196:199], v[84:87], v[56:59]
  ds_read_b64 v[240:241], v16 offset:1664
  v_mfma_f32_16x16x32_bf16 v[60:63], v[196:199], v[88:91], v[60:63]
  ds_read_b64 v[242:243], v16 offset:1672
  v_mfma_f32_16x16x32_bf16 v[52:55], v[64:67], v[212:215], v[52:55]
  ds_read_b128 v[228:231], v13 offset:10240
  s_waitcnt lgkmcnt(8)
  v_mfma_f32_16x16x32_bf16 v[56:59], v[68:71], v[212:215], v[56:59]
  ds_read_b64 v[244:245], v16 offset:1152
  v_mfma_f32_16x16x32_bf16 v[60:63], v[72:75], v[212:215], v[60:63]
  ds_read_b64 v[246:247], v16 offset:1160
  v_mfma_f32_16x16x32_bf16 v[56:59], v[200:203], v[80:83], v[56:59]
  ds_read_b128 v[232:235], v13 offset:12288
  v_mfma_f32_16x16x32_bf16 v[60:63], v[200:203], v[84:87], v[60:63]
  ds_read_b64 v[248:249], v16 offset:640
  v_mfma_f32_16x16x32_bf16 v[56:59], v[64:67], v[216:219], v[56:59]
  ds_read_b64 v[250:251], v16 offset:648
  v_mfma_f32_16x16x32_bf16 v[60:63], v[68:71], v[216:219], v[60:63]
  ds_read_b128 v[236:239], v13 offset:14336
  v_mfma_f32_16x16x32_bf16 v[60:63], v[204:207], v[80:83], v[60:63]
  ds_read_b64 v[252:253], v16 offset:128
  v_mfma_f32_16x16x32_bf16 v[60:63], v[64:67], v[220:223], v[60:63]
  ds_read_b64 v[254:255], v16 offset:136
  v_mfma_f32_16x16x32_bf16 v[48:51], v[108:111], v[116:119], v[48:51]
  v_mfma_f32_16x16x32_bf16 v[52:55], v[108:111], v[120:123], v[52:55]
  v_mfma_f32_16x16x32_bf16 v[48:51], v[104:107], v[120:123], v[48:51]
  v_mfma_f32_16x16x32_bf16 v[52:55], v[104:107], v[124:127], v[52:55]
  v_mfma_f32_16x16x32_bf16 v[48:51], v[100:103], v[124:127], v[48:51]
  v_mfma_f32_16x16x32_bf16 v[56:59], v[108:111], v[124:127], v[56:59]
  s_waitcnt lgkmcnt(0)
  v_mfma_f32_16x16x32_bf16 v[48:51], v[224:227], v[112:115], v[48:51]
  ds_read_b128 v[192:195], v14 offset:8192
  v_add_f32 v32, v32, v40
  v_mfma_f32_16x16x32_bf16 v[52:55], v[224:227], v[116:119], v[52:55]
  ds_read_b64 v[208:209], v16 offset:1600
  v_add_f32 v33, v33, v41
  v_mfma_f32_16x16x32_bf16 v[56:59], v[224:227], v[120:123], v[56:59]
  ds_read_b64 v[210:211], v16 offset:1608
  v_add_f32 v34, v34, v42
  v_mfma_f32_16x16x32_bf16 v[60:63], v[224:227], v[124:127], v[60:63]
  ds_read_b128 v[196:199], v14 offset:10240
  v_add_f32 v35, v35, v43
  v_mfma_f32_16x16x32_bf16 v[48:51], v[96:99], v[240:243], v[48:51]
  ds_read_b64 v[212:213], v16 offset:1088
  v_add_f32 v36, v36, v44
  v_mfma_f32_16x16x32_bf16 v[52:55], v[100:103], v[240:243], v[52:55]
  ds_read_b64 v[214:215], v16 offset:1096
  v_add_f32 v37, v37, v45
  v_mfma_f32_16x16x32_bf16 v[56:59], v[104:107], v[240:243], v[56:59]
  ds_read_b128 v[200:203], v14 offset:12288
  v_add_f32 v38, v38, v46
  v_mfma_f32_16x16x32_bf16 v[60:63], v[108:111], v[240:243], v[60:63]
  ds_read_b64 v[216:217], v16 offset:576
  v_add_f32 v39, v39, v47
  v_mfma_f32_16x16x32_bf16 v[52:55], v[228:231], v[112:115], v[52:55]
  ds_read_b64 v[218:219], v16 offset:584
  v_cvt_pk_bf16_f32 v22, v32, v34
  v_mfma_f32_16x16x32_bf16 v[56:59], v[228:231], v[116:119], v[56:59]
  ds_read_b128 v[204:207], v14 offset:14336
  v_cvt_pk_bf16_f32 v23, v36, v38
  v_mfma_f32_16x16x32_bf16 v[60:63], v[228:231], v[120:123], v[60:63]
  ds_read_b64 v[220:221], v16 offset:64
  buffer_store_dwordx2 v[22:23], v19, s[52:55], s60 offen
  v_mfma_f32_16x16x32_bf16 v[52:55], v[96:99], v[244:247], v[52:55]
  ds_read_b64 v[222:223], v16 offset:72
  s_waitcnt lgkmcnt(8)
  v_cvt_pk_bf16_f32 v24, v33, v35
  v_mfma_f32_16x16x32_bf16 v[56:59], v[100:103], v[244:247], v[56:59]
  v_cvt_pk_bf16_f32 v25, v37, v39
  v_mfma_f32_16x16x32_bf16 v[60:63], v[104:107], v[244:247], v[60:63]
  buffer_store_dwordx2 v[24:25], v19, s[52:55], s61 offen
  v_mfma_f32_16x16x32_bf16 v[56:59], v[232:235], v[112:115], v[56:59]
  v_mfma_f32_16x16x32_bf16 v[60:63], v[232:235], v[116:119], v[60:63]
  v_mfma_f32_16x16x32_bf16 v[56:59], v[96:99], v[248:251], v[56:59]
  v_mfma_f32_16x16x32_bf16 v[60:63], v[100:103], v[248:251], v[60:63]
  v_mfma_f32_16x16x32_bf16 v[60:63], v[236:239], v[112:115], v[60:63]
  v_mfma_f32_16x16x32_bf16 v[60:63], v[96:99], v[252:255], v[60:63]
  v_mfma_f32_16x16x32_bf16 v[48:51], v[140:143], v[148:151], v[48:51]
  v_mfma_f32_16x16x32_bf16 v[52:55], v[140:143], v[152:155], v[52:55]
  v_mfma_f32_16x16x32_bf16 v[48:51], v[136:139], v[152:155], v[48:51]
  v_mfma_f32_16x16x32_bf16 v[52:55], v[136:139], v[156:159], v[52:55]
  v_mfma_f32_16x16x32_bf16 v[48:51], v[132:135], v[156:159], v[48:51]
  v_mfma_f32_16x16x32_bf16 v[56:59], v[140:143], v[156:159], v[56:59]
  s_waitcnt lgkmcnt(0)
  v_mfma_f32_16x16x32_bf16 v[48:51], v[192:195], v[144:147], v[48:51]
  ds_read_b128 v[224:227], v15 offset:8192
  v_mfma_f32_16x16x32_bf16 v[52:55], v[192:195], v[148:151], v[52:55]
  ds_read_b64 v[240:241], v16 offset:1536
  v_mfma_f32_16x16x32_bf16 v[56:59], v[192:195], v[152:155], v[56:59]
  ds_read_b64 v[242:243], v16 offset:1544
  v_mfma_f32_16x16x32_bf16 v[60:63], v[192:195], v[156:159], v[60:63]
  ds_read_b128 v[228:231], v15 offset:10240
  v_mfma_f32_16x16x32_bf16 v[48:51], v[128:131], v[208:211], v[48:51]
  ds_read_b64 v[244:245], v16 offset:1024
  v_mfma_f32_16x16x32_bf16 v[52:55], v[132:135], v[208:211], v[52:55]
  ds_read_b64 v[246:247], v16 offset:1032
  v_mfma_f32_16x16x32_bf16 v[56:59], v[136:139], v[208:211], v[56:59]
  ds_read_b128 v[232:235], v15 offset:12288
  v_mfma_f32_16x16x32_bf16 v[60:63], v[140:143], v[208:211], v[60:63]
  ds_read_b64 v[248:249], v16 offset:512
  v_mfma_f32_16x16x32_bf16 v[52:55], v[196:199], v[144:147], v[52:55]
  ds_read_b64 v[250:251], v16 offset:520
  v_mfma_f32_16x16x32_bf16 v[56:59], v[196:199], v[148:151], v[56:59]
  ds_read_b128 v[236:239], v15 offset:14336
  v_mfma_f32_16x16x32_bf16 v[60:63], v[196:199], v[152:155], v[60:63]
  ds_read_b64 v[252:253], v16 offset:0
  v_mfma_f32_16x16x32_bf16 v[52:55], v[128:131], v[212:215], v[52:55]
  ds_read_b64 v[254:255], v16 offset:8
  s_waitcnt lgkmcnt(8)
  v_mfma_f32_16x16x32_bf16 v[56:59], v[132:135], v[212:215], v[56:59]
  v_mfma_f32_16x16x32_bf16 v[60:63], v[136:139], v[212:215], v[60:63]
  v_mfma_f32_16x16x32_bf16 v[56:59], v[200:203], v[144:147], v[56:59]
  v_mfma_f32_16x16x32_bf16 v[60:63], v[200:203], v[148:151], v[60:63]
  v_mfma_f32_16x16x32_bf16 v[56:59], v[128:131], v[216:219], v[56:59]
  v_mfma_f32_16x16x32_bf16 v[60:63], v[132:135], v[216:219], v[60:63]
  v_mfma_f32_16x16x32_bf16 v[60:63], v[204:207], v[144:147], v[60:63]
  v_mfma_f32_16x16x32_bf16 v[60:63], v[128:131], v[220:223], v[60:63]
  v_mfma_f32_16x16x32_bf16 v[48:51], v[172:175], v[180:183], v[48:51]
  v_mfma_f32_16x16x32_bf16 v[52:55], v[172:175], v[184:187], v[52:55]
  v_mfma_f32_16x16x32_bf16 v[48:51], v[168:171], v[184:187], v[48:51]
  v_mfma_f32_16x16x32_bf16 v[52:55], v[168:171], v[188:191], v[52:55]
  v_mfma_f32_16x16x32_bf16 v[48:51], v[164:167], v[188:191], v[48:51]
  v_mfma_f32_16x16x32_bf16 v[56:59], v[172:175], v[188:191], v[56:59]
  s_waitcnt lgkmcnt(0)
  v_mfma_f32_16x16x32_bf16 v[48:51], v[224:227], v[176:179], v[48:51]
  v_mfma_f32_16x16x32_bf16 v[52:55], v[224:227], v[180:183], v[52:55]
  v_mfma_f32_16x16x32_bf16 v[56:59], v[224:227], v[184:187], v[56:59]
  v_mfma_f32_16x16x32_bf16 v[60:63], v[224:227], v[188:191], v[60:63]
  v_mfma_f32_16x16x32_bf16 v[48:51], v[160:163], v[240:243], v[48:51]
  v_mfma_f32_16x16x32_bf16 v[52:55], v[164:167], v[240:243], v[52:55]
  v_mfma_f32_16x16x32_bf16 v[56:59], v[168:171], v[240:243], v[56:59]
  v_mfma_f32_16x16x32_bf16 v[60:63], v[172:175], v[240:243], v[60:63]
  v_mfma_f32_16x16x32_bf16 v[52:55], v[228:231], v[176:179], v[52:55]
  v_mfma_f32_16x16x32_bf16 v[56:59], v[228:231], v[180:183], v[56:59]
  v_mfma_f32_16x16x32_bf16 v[60:63], v[228:231], v[184:187], v[60:63]
  v_mfma_f32_16x16x32_bf16 v[52:55], v[160:163], v[244:247], v[52:55]
  v_mfma_f32_16x16x32_bf16 v[56:59], v[164:167], v[244:247], v[56:59]
  v_mfma_f32_16x16x32_bf16 v[60:63], v[168:171], v[244:247], v[60:63]
  v_mfma_f32_16x16x32_bf16 v[56:59], v[232:235], v[176:179], v[56:59]
  v_mfma_f32_16x16x32_bf16 v[60:63], v[232:235], v[180:183], v[60:63]
  v_mfma_f32_16x16x32_bf16 v[56:59], v[160:163], v[248:251], v[56:59]
  v_mfma_f32_16x16x32_bf16 v[60:63], v[164:167], v[248:251], v[60:63]
  v_mfma_f32_16x16x32_bf16 v[60:63], v[236:239], v[176:179], v[60:63]
  v_mfma_f32_16x16x32_bf16 v[60:63], v[160:163], v[252:255], v[60:63]
  s_add_u32 s60, s60, 1835008
  s_add_u32 s61, s61, 1835008
  s_nop 5
  ds_write_b128 v17, v[48:51] offset:32768
  ds_write_b128 v17, v[52:55] offset:33792
  ds_write_b128 v17, v[56:59] offset:34816
  ds_write_b128 v17, v[60:63] offset:35840
  s_waitcnt lgkmcnt(0)
  s_barrier
  ds_read_b64 v[32:33], v18 offset:32768
  ds_read_b64 v[34:35], v18 offset:36864
  ds_read_b64 v[36:37], v18 offset:40960
  ds_read_b64 v[38:39], v18 offset:45056
  ds_read_b64 v[40:41], v18 offset:49152
  ds_read_b64 v[42:43], v18 offset:53248
  ds_read_b64 v[44:45], v18 offset:57344
  ds_read_b64 v[46:47], v18 offset:61440
  s_waitcnt lgkmcnt(0)
  v_add_f32 v32, v32, v40
  v_add_f32 v33, v33, v41
  v_add_f32 v34, v34, v42
  v_add_f32 v35, v35, v43
  v_add_f32 v36, v36, v44
  v_add_f32 v37, v37, v45
  v_add_f32 v38, v38, v46
  v_add_f32 v39, v39, v47
  v_cvt_pk_bf16_f32 v22, v32, v34
  v_cvt_pk_bf16_f32 v23, v36, v38
  buffer_store_dwordx2 v[22:23], v19, s[52:55], s60 offen
  v_cvt_pk_bf16_f32 v24, v33, v35
  v_cvt_pk_bf16_f32 v25, v37, v39
  buffer_store_dwordx2 v[24:25], v19, s[52:55], s61 offen
  s_endpgm
L_end:
  s_endpgm
  .fill 2048, 4, 0xbf800000
.section .rodata,"a"
.p2align 6
.amdhsa_kernel concat_heads__ssm_conv_s4d__linear_attn_block__prompt_kernel
  .amdhsa_next_free_vgpr 256
  .amdhsa_next_free_sgpr 100
  .amdhsa_accum_offset 256
  .amdhsa_group_segment_fixed_size 0
  .amdhsa_kernarg_size 104
  .amdhsa_user_sgpr_count 2
  .amdhsa_user_sgpr_kernarg_segment_ptr 1
  .amdhsa_system_sgpr_workgroup_id_x 1
.end_amdhsa_kernel
```
